```python
import torch

def _softmax(x, axis=-1):
    return torch.softmax(x, dim=axis)
def _gelu(x):
    return torch.nn.functional.gelu(x, approximate="tanh")
def _silu(x):
    return torch.nn.functional.silu(x)
def _sigmoid(x):
    return torch.sigmoid(x)
def _layernorm(x, axis=-1, eps=1e-5):
    m = x.mean(dim=axis, keepdim=True)
    v = x.var(dim=axis, keepdim=True, unbiased=False)
    return (x - m) / torch.sqrt(v + eps)
def _scatter_add(tgt, idx, src, axis=0):
    return tgt.clone().index_add_(axis, idx, src)
def _segment_sum(src, seg, n):
    out = torch.zeros((n,) + src.shape[1:], dtype=src.dtype)
    return out.index_add_(0, seg, src)
def _pad(x, pw):
    flat = tuple(v for pair in reversed(pw) for v in pair)
    return torch.nn.functional.pad(x, flat)

kernel_name = 'interleave_layers__linear_kernel_hedgehog__linear_kernel_hedgehog__prompt'

def setup_inputs():

    _w = (lambda a: (lambda t: t.to(torch.bfloat16) if t.is_floating_point() else t)(torch.as_tensor(a)))
    def _A_setup():
        B, S, D, H = 1, 2048, 512, 32
        Dh = D // H
        return {
            "x": _w((lambda *s: torch.randn(*s, dtype=torch.bfloat16) * 0.1)(B, S, D)),
            "wqkv": _w((lambda *s: torch.randn(*s, dtype=torch.bfloat16) * 0.4)(D, 3 * D)),
            "w_phi": _w((lambda *s: torch.randn(*s, dtype=torch.bfloat16) * 0.4)(H, Dh, Dh) * (Dh ** -0.5)),
            "wo": _w((lambda *s: torch.randn(*s, dtype=torch.bfloat16) * 0.1)(D, D)),
        }
    _A_in = _A_setup()

    def _B_setup():
        B, S, D, H = 1, 2048, 512, 32
        Dh = D // H
        return {
            "x": _w((lambda *s: torch.randn(*s, dtype=torch.bfloat16) * 0.1)(B, S, D)),
            "wqkv": _w((lambda *s: torch.randn(*s, dtype=torch.bfloat16) * 0.8)(D, 3 * D)),
            "w_phi": _w((lambda *s: torch.randn(*s, dtype=torch.bfloat16) * 0.8)(H, Dh, Dh) * (Dh ** -0.5)),
            "wo": _w((lambda *s: torch.randn(*s, dtype=torch.bfloat16) * 0.1)(D, D)),
        }
    _B_in = _B_setup()

    return {
        "A_x": _A_in["x"],
        "A_wqkv": _A_in["wqkv"],
        "A_w_phi": _A_in["w_phi"],
        "A_wo": _A_in["wo"],
        "B_x": _B_in["x"],
        "B_wqkv": _B_in["wqkv"],
        "B_w_phi": _B_in["w_phi"],
        "B_wo": _B_in["wo"],
    }

def reference(A_x, A_wqkv, A_w_phi, A_wo, B_x, B_wqkv, B_w_phi, B_wo):
    def _A_ref(x, wqkv, w_phi, wo):
        B, S, D = x.shape
        H = 32; Dh = D // H
        qkv = (lambda x, *d: x.permute(*d))((x @ wqkv).reshape(B, S, 3, H, Dh), 2, 0, 3, 1, 4)
        q, k, v = qkv[0], qkv[1], qkv[2]
        pq = torch.einsum("bhsd,hdf->bhsf", q, w_phi)
        pk = torch.einsum("bhsd,hdf->bhsf", k, w_phi)
        phi_q = torch.concatenate([_softmax(pq, axis=-1), _softmax(-pq, axis=-1)], axis=-1)
        phi_k = torch.concatenate([_softmax(pk, axis=-1), _softmax(-pk, axis=-1)], axis=-1)
        kv = torch.einsum("bhsf,bhsd->bhfd", phi_k, v)
        z  = torch.einsum("bhsf->bhf", phi_k)
        num = torch.einsum("bhqf,bhfd->bhqd", phi_q, kv)
        den = torch.einsum("bhqf,bhf->bhq", phi_q, z)[..., None] + 1e-6
        o = num / den
        return (lambda x, *d: x.permute(*d))(o, 0, 2, 1, 3).reshape(B, S, D) @ wo

    def _B_ref(x, wqkv, w_phi, wo):
        B, S, D = x.shape
        H = 32; Dh = D // H
        qkv = (lambda x, *d: x.permute(*d))((x @ wqkv).reshape(B, S, 3, H, Dh), 2, 0, 3, 1, 4)
        q, k, v = qkv[0], qkv[1], qkv[2]
        pq = torch.einsum("bhsd,hdf->bhsf", q, w_phi)
        pk = torch.einsum("bhsd,hdf->bhsf", k, w_phi)
        phi_q = torch.concatenate([_softmax(pq, axis=-1), _softmax(-pq, axis=-1)], axis=-1)
        phi_k = torch.concatenate([_softmax(pk, axis=-1), _softmax(-pk, axis=-1)], axis=-1)
        kv = torch.einsum("bhsf,bhsd->bhfd", phi_k, v)
        z  = torch.einsum("bhsf->bhf", phi_k)
        num = torch.einsum("bhqf,bhfd->bhqd", phi_q, kv)
        den = torch.einsum("bhqf,bhf->bhq", phi_q, z)[..., None] + 1e-6
        o = num / den
        return (lambda x, *d: x.permute(*d))(o, 0, 2, 1, 3).reshape(B, S, D) @ wo

    x = A_x
    x = x + _A_ref(_layernorm(x, axis=-1), A_wqkv, A_w_phi, A_wo)
    x = x + _B_ref(_layernorm(x, axis=-1), B_wqkv, B_w_phi, B_wo)
    x = x + _A_ref(_layernorm(x, axis=-1), A_wqkv, A_w_phi, A_wo)
    x = x + _B_ref(_layernorm(x, axis=-1), B_wqkv, B_w_phi, B_wo)
    return x
```

```asm
; @launch grid=(256,1,1) block=(512,1,1) lds=163840
.amdgcn_target "amdgcn-amd-amdhsa--gfx950"
.text
.p2align 11
.fill 320, 4, 0xbf810000
.globl interleave_layers__linear_kernel_hedgehog__linear_kernel_hedgehog__prompt_kernel
.p2align 8
.type interleave_layers__linear_kernel_hedgehog__linear_kernel_hedgehog__prompt_kernel,@function
interleave_layers__linear_kernel_hedgehog__linear_kernel_hedgehog__prompt_kernel:
 s_cmp_ge_u32 s2, 256
 s_cbranch_scc1 Lexit2
 s_load_dwordx16 s[4:19], s[0:1], 0
 s_load_dwordx4 s[20:23], s[0:1], 64
 s_load_dwordx2 s[24:25], s[0:1], 80
 s_getpc_b64 s[26:27]
Lpc:
 v_lshrrev_b32 v54, 5, v0
 s_lshr_b32 s62, s2, 3
 s_mov_b32 exec_lo, 0x01010101
 s_mov_b32 exec_hi, 0x01010101
 s_lshl_b32 s88, s62, 11
 s_and_b32 s90, s2, 7
 v_lshl_add_u32 v50, v54, 7, s88
 v_min_u32 v50, Lend-Lpc-64, v50
 s_lshl_b32 s88, s90, 5
 s_add_u32 s88, s88, s62
 global_load_dword v17, v50, s[26:27]
 s_lshl_b32 s88, s88, 13
 s_lshl_b32 s90, s90, 7
 v_lshl_add_u32 v52, v0, 4, s88
 s_mul_i32 s88, s62, 49152
 v_min_u32 v53, 376, v0
 s_add_u32 s88, s88, s90
 s_lshl_b32 s89, s62, 14
 v_lshl_add_u32 v53, v53, 7, s88
 s_add_u32 s89, s89, s90
 v_lshl_add_u32 v54, v54, 10, s89
 s_waitcnt lgkmcnt(0)
 global_load_dword v17, v52, s[4:5]
 s_mul_i32 s88, s62, 49152
 v_min_u32 v55, 376, v0
 s_add_u32 s88, s88, 0
 v_lshl_add_u32 v55, v55, 7, s88
 global_load_dword v17, v53, s[6:7]
 global_load_dword v17, v55, s[6:7] offset:384
 s_mov_b64 exec, -1
 v_lshrrev_b32 v50, 6, v0
 v_and_b32 v40, 63, v0
 v_readfirstlane_b32 s66, v50
 v_lshrrev_b32 v48, 4, v40
 v_and_b32_e64 v47, 15, v40
 s_and_b32 s60, s66, 3
 s_lshl_b32 s91, s62, 2
 s_add_u32 s91, s91, s60
 s_and_b32 s61, s2, 7
 s_lshl_b32 s61, s61, 1
 s_lshr_b32 s88, s2, 7
 s_add_u32 s61, s61, s88
 s_and_b32 s62, s62, 15
 s_mov_b32 s64, 0x80000
 s_mov_b32 s94, 0x3f803f80
 s_mov_b32 s67, s2
 v_lshlrev_b32 v1, 4, v40
 v_lshlrev_b32_e64 v7, 3, v48
 v_lshl_add_u32 v7, v47, 5, v7
 v_cmp_lt_u32 vcc, 0, v47
 v_mov_b32 v51, 0x40000000
 v_lshlrev_b32_e64 v50, 2, v47
 v_add_u32 v50, 162304, v50
 v_cndmask_b32 v7, v7, v51, vcc
 v_mov_b32 v51, 0
 ds_write_b32 v50, v51
 s_mov_b32 s28, s24
 s_mov_b32 s29, s25
 s_mov_b32 s30, 17825792
 s_mov_b32 s31, 0x20000
 s_mov_b32 s36, s20
 s_mov_b32 s37, s21
 s_mov_b32 s38, 2097152
 s_mov_b32 s39, 0x20000
 s_cmp_lt_u32 s66, 4
 s_cbranch_scc1 Lcomp
 s_setprio 2
 s_mov_b32 s44, s6
 s_mov_b32 s45, s7
 s_mov_b32 s46, 1572864
 s_mov_b32 s47, 0x20000
 s_mov_b32 s48, s14
 s_mov_b32 s49, s15
 s_mov_b32 s50, 1572864
 s_mov_b32 s51, 0x20000
 s_mov_b32 s52, s10
 s_mov_b32 s53, s11
 s_mov_b32 s54, 524288
 s_mov_b32 s55, 0x20000
 s_mov_b32 s56, s18
 s_mov_b32 s57, s19
 s_mov_b32 s58, 524288
 s_mov_b32 s59, 0x20000
 s_mov_b32 s32, s22
 s_mov_b32 s33, s23
 s_mov_b32 s34, 256
 s_mov_b32 s35, 0x20000
 s_lshl_b32 s78, s91, 12
 s_mul_i32 s79, s78, 3
 v_lshlrev_b32 v8, 7, v40
 v_and_b32 v9, 0xc00, v8
 v_lshl_add_u32 v9, v9, 1, v8
 s_mul_i32 s88, s62, 40960
 s_lshl_b32 s4, s60, 13
 s_add_u32 s4, s4, s88
 s_add_u32 s4, s4, 2359296
 s_lshl_b32 s5, s61, 9
 s_add_u32 s5, s5, s4
 s_mul_i32 s6, s60, 32
 s_add_u32 s6, s6, s88
 s_add_u32 s6, s6, 2392064
 s_mul_i32 s7, s61, 128
 s_add_u32 s7, s7, s6
 s_lshl_b32 s88, s61, 2
 s_add_u32 s88, s88, s60
 s_mul_i32 s13, s88, 34944
 s_lshl_b32 s10, s62, 10
 s_add_u32 s10, s10, s13
 s_lshl_b32 s12, s62, 7
 s_add_u32 s12, s12, s13
 s_add_u32 s12, s12, 32768
 s_lshl_b32 s11, s88, 4
 s_add_u32 s11, s11, s62
 s_lshl_b32 s11, s11, 11
 s_add_u32 s13, s13, 34816
 v_mov_b32 v224, -1
 v_mov_b32 v225, -1
 v_mov_b32 v226, -1
 v_mov_b32 v227, -1
 v_mov_b32 v228, 0
 v_mov_b32 v229, 0
 v_mov_b32 v230, 0
 v_mov_b32 v231, 0
 v_lshlrev_b32 v3, 3, v40
 s_lshl_b32 s15, s61, 4
 buffer_store_dwordx2 v[224:225], v3, s[28:31], s5 offen sc1
 buffer_store_dwordx2 v[224:225], v7, s[28:31], s7 offen sc1
 buffer_load_dwordx4 v[236:239], v228, s[32:35], s15 offen sc1
 s_lshl_b32 s88, s62, 2
 s_add_u32 s88, s88, s13
 s_mov_b64 exec, 1
 buffer_store_dword v224, v1, s[28:31], s88 offen sc1
 s_mov_b64 exec, -1
 s_and_b32 s88, s67, 7
 s_lshl_b32 s88, s88, 7
 s_add_u32 s88, s88, s78
 v_lshlrev_b32_e64 v11, 6, v1
 s_mov_b64 exec, 15
 buffer_load_dword v14, v11, s[52:55], s88 offen
 s_mov_b64 exec, -1
 s_and_b32 s88, s67, 7
 s_lshl_b32 s88, s88, 7
 s_add_u32 s88, s88, s79
 v_lshlrev_b32_e64 v11, 6, v1
 s_mov_b64 exec, 2340
 buffer_load_dword v14, v11, s[48:51], s88 offen
 s_mov_b64 exec, -1
 s_and_b32 s88, s67, 7
 s_lshl_b32 s88, s88, 7
 s_add_u32 s88, s88, s79
 v_lshlrev_b32_e64 v11, 6, v1
 s_mov_b64 exec, 1170
 buffer_load_dword v14, v11, s[48:51], s88 offen
 s_mov_b64 exec, -1
 s_setprio 0
 s_branch Lhelper
Lcomp:
 s_setprio 1
 s_mov_b32 s40, s4
 s_mov_b32 s41, s5
 s_mov_b32 s42, 2097152
 s_mov_b32 s43, 0x20000
 v_and_b32 v45, 3, v40
 v_lshrrev_b32 v42, 5, v40
 v_bfe_u32 v43, v40, 4, 1
 v_bfe_u32 v44, v40, 2, 2
 v_lshrrev_b32_e64 v46, 2, v40
 v_lshl_add_u32 v50, v42, 2, v44
 v_lshlrev_b32_e64 v50, 6, v50
 v_lshl_add_u32 v50, v43, 5, v50
 v_lshl_add_u32 v2, v45, 3, v50
 v_bfe_u32 v50, v40, 1, 2
 v_xor_b32 v50, v50, v48
 v_lshrrev_b32 v51, 3, v40
 v_lshlrev_b32_e64 v5, 10, v51
 v_lshl_add_u32 v5, v50, 5, v5
 v_and_b32_e64 v50, 1, v40
 v_lshl_add_u32 v5, v50, 4, v5
 s_lshl_b32 s88, s61, 1
 s_and_b32 s89, s62, 1
 s_add_u32 s88, s88, s89
 s_lshl_b32 s88, s88, 2
 s_add_u32 s88, s88, s60
 s_lshl_b32 s95, s88, 14
 s_lshr_b32 s89, s62, 1
 s_lshl_b32 s89, s89, 7
 s_add_u32 s95, s95, s89
 s_and_b32 s90, s60, 1
 s_mov_b32 s24, s8
 s_mov_b32 s25, s9
 s_mov_b32 s26, 16384
 s_mov_b32 s27, 0x20000
 s_lshl_b32 s89, s60, 8
 s_add_u32 m0, s89, 157184
 s_lshl_b32 s88, s62, 10
 s_add_u32 s88, s88, s89
 s_mov_b64 exec, 0xffff
 buffer_load_dwordx4 v1, s[24:27], s88 offen lds
 s_mov_b64 exec, -1
 s_lshl_b32 s88, s61, 2
 s_add_u32 s89, s88, s60
 s_lshl_b32 s68, s89, 15
 s_mul_i32 s91, s89, 34944
 s_and_b32 s89, s62, 1
 s_lshl_b32 s89, s89, 1
 s_add_u32 s88, s88, s89
 s_lshr_b32 s89, s60, 1
 s_add_u32 s88, s88, s89
 s_lshr_b32 s66, s62, 1
 s_lshl_b32 s10, s62, 10
 s_add_u32 s10, s10, s91
 s_add_u32 s15, s10, 16384
 s_add_u32 s76, s91, 32768
 s_lshl_b32 s13, s62, 2
 s_add_u32 s13, s13, s91
 s_add_u32 s13, s13, 34816
 s_mul_i32 s14, s88, 34944
 s_lshl_b32 s91, s90, 8
 s_add_u32 s77, s14, s91
 s_add_u32 s14, s14, 34816
 s_lshl_b32 s11, s88, 15
 s_add_u32 s11, s11, s91
 s_lshr_b32 s12, s66, 2
 s_lshl_b32 s12, s12, 9
 s_and_b32 s89, s66, 3
 s_lshl_b32 s89, s89, 2
 s_add_u32 s12, s12, s89
 s_add_u32 s12, s12, s77
 s_add_u32 s12, s12, 32768
 s_lshl_b32 s89, s66, 12
 s_add_u32 s11, s11, s89
 v_lshlrev_b32 v27, 3, v40
 v_lshlrev_b32 v0, 2, v47
 v_lshlrev_b32 v50, 4, v47
 v_lshl_add_u32 v31, v48, 9, v50
 v_lshl_add_u32 v29, v42, 9, v50
 v_xor_b32 v51, v44, v48
 v_xor_b32 v51, 1, v51
 v_lshl_add_u32 v29, v51, 9, v50
 v_lshrrev_b32_e64 v51, 1, v51
 v_lshl_add_u32 v29, v51, 30, v29
 v_xor_b32 v51, v44, v48
 v_min_u32 v51, 1, v51
 v_lshl_add_u32 v29, v51, 30, v50
 s_mov_b32 s44, 0xaaaaaaaa
 s_mov_b32 s45, 0xaaaaaaaa
 s_mov_b32 s46, 0xcccccccc
 s_mov_b32 s47, 0xcccccccc
 s_mov_b32 s48, 0x00f0000f
 s_mov_b32 s49, 0xf0000f00
 v_mov_b32_e64 v19, 0
 s_mul_i32 s88, s62, 40960
 s_lshl_b32 s4, s60, 13
 s_add_u32 s4, s4, s88
 s_add_u32 s4, s4, 2359296
 s_lshl_b32 s5, s61, 9
 s_add_u32 s5, s5, s4
 s_mul_i32 s6, s60, 32
 s_add_u32 s6, s6, s88
 s_add_u32 s6, s6, 2392064
 s_mul_i32 s7, s61, 128
 s_add_u32 s7, s7, s6
 v_and_b32 v41, 31, v40
 v_add_u32 v3, 65536, v2
 v_lshl_add_u32 v50, v43, 2, v44
 v_lshrrev_b32_e64 v51, 1, v50
 v_lshl_add_u32 v50, v42, 4, v50
 v_lshlrev_b32_e64 v50, 7, v50
 v_lshl_add_u32 v50, v51, 5, v50
 v_lshl_add_u32 v4, v45, 3, v50
 s_lshl_b32 s88, s60, 9
 s_add_u32 s88, s88, 131072
 v_lshl_add_u32 v50, v41, 4, s88
 v_mul_u32_u24 v51, 4352, v42
 v_add_u32 v8, v50, v51
 v_lshl_add_u32 v14, v41, 4, v51
 v_mul_u32_u24 v51, 2176, v42
 v_add_u32 v14, 131072, v14
 v_add_u32_e64 v9, v50, v51
 s_mul_i32 s88, s60, 4352
 s_add_u32 s88, s88, 131072
 s_lshr_b32 s89, s60, 1
 s_mul_i32 s89, s89, 4352
 s_add_u32 s89, s89, 148480
 v_lshrrev_b32 v50, 1, v45
 v_and_b32_e64 v51, 1, v45
 v_mul_u32_u24 v10, 2176, v50
 v_lshl_add_u32 v10, v51, 3, v10
 v_lshl_add_u32 v10, v46, 4, v10
 v_add_u32_e64 v10, s88, v10
 v_mul_u32_u24 v11, 2176, v51
 v_lshl_add_u32 v11, v50, 3, v11
 v_lshl_add_u32 v11, v46, 4, v11
 v_add_u32 v11, s89, v11
 s_lshl_b32 s88, s60, 11
 s_add_u32 s88, s88, 131072
 v_lshl_add_u32 v21, v47, 7, s88
 v_bfe_u32 v50, v40, 1, 2
 v_lshl_add_u32 v21, v50, 5, v21
 v_lshl_add_u32 v21, v48, 3, v21
 v_mov_b32 v23, 0
 v_mov_b32 v24, 0
 v_mov_b32 v25, 0
 v_mov_b32 v28, 0
 v_mov_b32_e64 v30, 0
 s_mov_b32 s86, 0
 s_mov_b32 s87, -1
 s_mov_b32 s85, 0
 s_mov_b32 s65, 0
 s_mov_b32 s66, 159232
 s_mov_b32 s17, 158208
 s_add_u32 s69, s68, 4096
 s_add_u32 s70, s68, 8192
 s_add_u32 s71, s68, 12288
 s_add_u32 s72, s68, 16384
 s_add_u32 s73, s68, 20480
 s_add_u32 s74, s68, 24576
 s_add_u32 s75, s68, 28672
 s_add_u32 s78, s77, 4096
 s_add_u32 s79, s77, 8192
 s_add_u32 s80, s77, 12288
 s_add_u32 s81, s77, 16384
 s_add_u32 s82, s77, 20480
 s_add_u32 s83, s77, 24576
 s_add_u32 s84, s77, 28672
 v_lshrrev_b32 v76, 3, v40
 v_and_b32 v77, 7, v40
 v_xor_b32 v77, v77, v48
 v_lshlrev_b32 v77, 4, v77
 v_lshl_add_u32 v76, v76, 10, v77
 v_xor_b32_e64 v77, 64, v76
 v_bfe_u32 v78, v40, 1, 3
 v_xor_b32 v78, v78, v42
 v_lshlrev_b32 v78, 4, v78
 v_lshl_add_u32 v78, v41, 7, v78
 s_lshl_b32 s16, s60, 12
 v_add_u32 v78, s16, v78
 v_xor_b32 v85, 65632, v78
 v_xor_b32 v84, 65600, v78
 v_xor_b32 v83, 65568, v78
 v_xor_b32 v82, 65536, v78
 v_xor_b32 v81, 32864, v78
 v_xor_b32 v80, 32832, v78
 v_xor_b32 v79, 32800, v78
 v_xor_b32 v78, 32768, v78
 v_mov_b32 v72, 0
 v_mov_b32 v73, 0
 v_mov_b32 v74, 0
 v_mov_b32 v75, 0
 v_mov_b32 v12, 162304
Lhop0:
 s_cbranch_execz Lhop4
 s_lshl_b32 s88, s60, 2
 s_add_u32 s89, s88, 162336
 v_mov_b32_e64 v13, s89
 s_add_u32 s88, s88, 159232
 v_lshl_add_u32 v6, v41, 4, s88
 s_lshl_b32 s88, s60, 13
 v_add_u32 v15, s88, v2
 v_lshrrev_b32 v112, 2, v1
 v_xor_b32 v112, v112, v1
 v_bfe_u32 v112, v112, 6, 1
 v_add_u32 v112, -1, v112
 v_and_b32 v112, s94, v112
 v_mov_b32 v113, v112
 v_mov_b32 v114, v112
 v_mov_b32 v115, v112
 s_lshl_b32 s89, s60, 11
 s_add_u32 m0, s89, 131072
 s_add_u32 s88, s95, 8192
 buffer_load_dwordx4 v5, s[40:43], s95 offen lds
 s_add_u32 m0, s89, 132096
 s_nop 0
 buffer_load_dwordx4 v5, s[40:43], s88 offen lds
 s_add_u32 m0, s16, 98304
 s_nop 0
 buffer_load_dwordx4 v76, s[40:43], s68 offen offset:0 nt lds
 s_add_u32 m0, s16, 99328
 s_nop 0
 buffer_load_dwordx4 v77, s[40:43], s70 offen offset:0 nt lds
 s_add_u32 m0, s16, 100352
 s_nop 0
 buffer_load_dwordx4 v76, s[40:43], s72 offen offset:0 nt lds
 s_add_u32 m0, s16, 101376
 s_nop 0
 buffer_load_dwordx4 v77, s[40:43], s74 offen offset:0 nt lds
 s_add_u32 m0, s16, 114560
 s_nop 0
 buffer_load_dwordx4 v76, s[40:43], s68 offen offset:128 nt lds
 s_add_u32 m0, s16, 115584
 s_nop 0
 buffer_load_dwordx4 v77, s[40:43], s70 offen offset:128 nt lds
 s_add_u32 m0, s16, 116608
 s_nop 0
 buffer_load_dwordx4 v76, s[40:43], s72 offen offset:128 nt lds
 s_add_u32 m0, s16, 117632
 s_nop 0
 buffer_load_dwordx4 v77, s[40:43], s74 offen offset:128 nt lds
 s_add_u32 m0, s16, 65280
 s_nop 0
 buffer_load_dwordx4 v76, s[40:43], s68 offen offset:256 nt lds
 s_add_u32 m0, s16, 66304
 s_nop 0
 buffer_load_dwordx4 v77, s[40:43], s70 offen offset:256 nt lds
 s_add_u32 m0, s16, 67328
 s_nop 0
 buffer_load_dwordx4 v76, s[40:43], s72 offen offset:256 nt lds
 s_add_u32 m0, s16, 68352
 s_nop 0
 buffer_load_dwordx4 v77, s[40:43], s74 offen offset:256 nt lds
 s_waitcnt vmcnt(12)
 ds_read_b64 v[120:121], v21
 v_xor_b32_e64 v57, 32, v21
 ds_read_b64 v[122:123], v57
 v_xor_b32_e64 v58, 64, v21
 ds_read_b64 v[124:125], v58
 v_xor_b32 v59, 96, v21
 ds_read_b64 v[126:127], v59
 s_waitcnt lgkmcnt(0)
 v_lshlrev_b32 v40, 16, v120
 v_and_b32 v41, 0xffff0000, v120
 v_lshlrev_b32_e64 v42, 16, v121
 v_and_b32 v43, 0xffff0000, v121
 v_lshlrev_b32_e64 v44, 16, v122
 v_and_b32 v45, 0xffff0000, v122
 v_lshlrev_b32_e64 v46, 16, v123
 v_and_b32 v47, 0xffff0000, v123
 v_lshlrev_b32_e64 v48, 16, v124
 v_and_b32 v49, 0xffff0000, v124
 v_lshlrev_b32_e64 v50, 16, v125
 v_and_b32 v51, 0xffff0000, v125
 v_lshlrev_b32_e64 v52, 16, v126
 v_and_b32 v53, 0xffff0000, v126
 v_lshlrev_b32_e64 v54, 16, v127
 v_and_b32 v55, 0xffff0000, v127
 s_waitcnt vmcnt(8)
 ds_read_b128 v[128:131], v82 offset:32768
 ds_read_b128 v[132:135], v83 offset:32768
 ds_read_b128 v[136:139], v84 offset:32768
 ds_read_b128 v[140:143], v85 offset:32768
 s_add_u32 m0, s16, 81536
 s_nop 0
 buffer_load_dwordx4 v76, s[40:43], s68 offen offset:384 nt lds
 s_add_u32 m0, s16, 82560
 s_nop 0
 buffer_load_dwordx4 v77, s[40:43], s70 offen offset:384 nt lds
 s_add_u32 m0, s16, 83584
 s_nop 0
 buffer_load_dwordx4 v76, s[40:43], s72 offen offset:384 nt lds
 s_add_u32 m0, s16, 84608
 s_nop 0
 buffer_load_dwordx4 v77, s[40:43], s74 offen offset:384 nt lds
 s_waitcnt vmcnt(8) lgkmcnt(0)
 ds_read_b128 v[144:147], v82 offset:49152
 ds_read_b128 v[148:151], v83 offset:49152
 ds_read_b128 v[152:155], v84 offset:49152
 ds_read_b128 v[156:159], v85 offset:49152
 s_add_u32 m0, s16, 97792
 v_dot2c_f32_bf16 v72, s94, v128
 v_dot2c_f32_bf16 v73, v128, v128
 buffer_load_dwordx4 v76, s[40:43], s68 offen offset:512 nt lds
 v_dot2c_f32_bf16 v74, s94, v129
 v_dot2c_f32_bf16 v75, v129, v129
 v_dot2c_f32_bf16 v72, s94, v130
 v_dot2c_f32_bf16 v73, v130, v130
 v_dot2c_f32_bf16 v74, s94, v131
 v_dot2c_f32_bf16 v75, v131, v131
 s_add_u32 m0, s16, 98816
 v_dot2c_f32_bf16 v72, s94, v132
 v_dot2c_f32_bf16 v73, v132, v132
 buffer_load_dwordx4 v77, s[40:43], s70 offen offset:512 nt lds
 v_dot2c_f32_bf16 v74, s94, v133
 v_dot2c_f32_bf16 v75, v133, v133
 v_dot2c_f32_bf16 v72, s94, v134
 v_dot2c_f32_bf16 v73, v134, v134
 v_dot2c_f32_bf16 v74, s94, v135
 v_dot2c_f32_bf16 v75, v135, v135
 s_add_u32 m0, s16, 99840
 v_dot2c_f32_bf16 v72, s94, v136
 v_dot2c_f32_bf16 v73, v136, v136
 buffer_load_dwordx4 v76, s[40:43], s72 offen offset:512 nt lds
 v_dot2c_f32_bf16 v74, s94, v137
 v_dot2c_f32_bf16 v75, v137, v137
 v_dot2c_f32_bf16 v72, s94, v138
 v_dot2c_f32_bf16 v73, v138, v138
 v_dot2c_f32_bf16 v74, s94, v139
 v_dot2c_f32_bf16 v75, v139, v139
 s_add_u32 m0, s16, 100864
 v_dot2c_f32_bf16 v72, s94, v140
 v_dot2c_f32_bf16 v73, v140, v140
 buffer_load_dwordx4 v77, s[40:43], s74 offen offset:512 nt lds
 v_dot2c_f32_bf16 v74, s94, v141
 v_dot2c_f32_bf16 v75, v141, v141
 v_dot2c_f32_bf16 v72, s94, v142
 v_dot2c_f32_bf16 v73, v142, v142
 v_dot2c_f32_bf16 v74, s94, v143
 v_dot2c_f32_bf16 v75, v143, v143
 s_waitcnt vmcnt(8) lgkmcnt(0)
 ds_read_b128 v[160:163], v82 offset:0
 ds_read_b128 v[164:167], v83 offset:0
 ds_read_b128 v[168:171], v84 offset:0
 ds_read_b128 v[172:175], v85 offset:0
 s_add_u32 m0, s16, 114048
 v_dot2c_f32_bf16 v72, s94, v144
 v_dot2c_f32_bf16 v73, v144, v144
 buffer_load_dwordx4 v76, s[40:43], s68 offen offset:640 nt lds
 v_dot2c_f32_bf16 v74, s94, v145
 v_dot2c_f32_bf16 v75, v145, v145
 v_dot2c_f32_bf16 v72, s94, v146
 v_dot2c_f32_bf16 v73, v146, v146
 v_dot2c_f32_bf16 v74, s94, v147
 v_dot2c_f32_bf16 v75, v147, v147
 s_add_u32 m0, s16, 115072
 v_dot2c_f32_bf16 v72, s94, v148
 v_dot2c_f32_bf16 v73, v148, v148
 buffer_load_dwordx4 v77, s[40:43], s70 offen offset:640 nt lds
 v_dot2c_f32_bf16 v74, s94, v149
 v_dot2c_f32_bf16 v75, v149, v149
 v_dot2c_f32_bf16 v72, s94, v150
 v_dot2c_f32_bf16 v73, v150, v150
 v_dot2c_f32_bf16 v74, s94, v151
 v_dot2c_f32_bf16 v75, v151, v151
 s_add_u32 m0, s16, 116096
 v_dot2c_f32_bf16 v72, s94, v152
 v_dot2c_f32_bf16 v73, v152, v152
 buffer_load_dwordx4 v76, s[40:43], s72 offen offset:640 nt lds
 v_dot2c_f32_bf16 v74, s94, v153
 v_dot2c_f32_bf16 v75, v153, v153
 v_dot2c_f32_bf16 v72, s94, v154
 v_dot2c_f32_bf16 v73, v154, v154
 v_dot2c_f32_bf16 v74, s94, v155
 v_dot2c_f32_bf16 v75, v155, v155
 s_add_u32 m0, s16, 117120
 v_dot2c_f32_bf16 v72, s94, v156
 v_dot2c_f32_bf16 v73, v156, v156
 buffer_load_dwordx4 v77, s[40:43], s74 offen offset:640 nt lds
 s_barrier
 v_dot2c_f32_bf16 v74, s94, v157
 v_dot2c_f32_bf16 v75, v157, v157
 v_dot2c_f32_bf16 v72, s94, v158
 v_dot2c_f32_bf16 v73, v158, v158
 v_dot2c_f32_bf16 v74, s94, v159
 v_dot2c_f32_bf16 v75, v159, v159
 s_waitcnt vmcnt(8) lgkmcnt(0)
 ds_read_b128 v[176:179], v82 offset:16384
 ds_read_b128 v[180:183], v83 offset:16384
 ds_read_b128 v[184:187], v84 offset:16384
 ds_read_b128 v[188:191], v85 offset:16384
 s_add_u32 m0, s16, 64768
 v_dot2c_f32_bf16 v72, s94, v160
 v_dot2c_f32_bf16 v73, v160, v160
 buffer_load_dwordx4 v76, s[40:43], s68 offen offset:768 nt lds
 v_dot2c_f32_bf16 v74, s94, v161
 v_dot2c_f32_bf16 v75, v161, v161
 v_dot2c_f32_bf16 v72, s94, v162
 v_dot2c_f32_bf16 v73, v162, v162
 v_dot2c_f32_bf16 v74, s94, v163
 v_dot2c_f32_bf16 v75, v163, v163
 s_add_u32 m0, s16, 65792
 v_dot2c_f32_bf16 v72, s94, v164
 v_dot2c_f32_bf16 v73, v164, v164
 buffer_load_dwordx4 v77, s[40:43], s70 offen offset:768 nt lds
 v_dot2c_f32_bf16 v74, s94, v165
 v_dot2c_f32_bf16 v75, v165, v165
 v_dot2c_f32_bf16 v72, s94, v166
 v_dot2c_f32_bf16 v73, v166, v166
 v_dot2c_f32_bf16 v74, s94, v167
 v_dot2c_f32_bf16 v75, v167, v167
 s_add_u32 m0, s16, 66816
 v_dot2c_f32_bf16 v72, s94, v168
 v_dot2c_f32_bf16 v73, v168, v168
 buffer_load_dwordx4 v76, s[40:43], s72 offen offset:768 nt lds
 v_dot2c_f32_bf16 v74, s94, v169
 v_dot2c_f32_bf16 v75, v169, v169
 v_dot2c_f32_bf16 v72, s94, v170
 v_dot2c_f32_bf16 v73, v170, v170
 v_dot2c_f32_bf16 v74, s94, v171
 v_dot2c_f32_bf16 v75, v171, v171
 s_add_u32 m0, s16, 67840
 v_dot2c_f32_bf16 v72, s94, v172
 v_dot2c_f32_bf16 v73, v172, v172
 buffer_load_dwordx4 v77, s[40:43], s74 offen offset:768 nt lds
 v_dot2c_f32_bf16 v74, s94, v173
 v_dot2c_f32_bf16 v75, v173, v173
 v_dot2c_f32_bf16 v72, s94, v174
 v_dot2c_f32_bf16 v73, v174, v174
 v_dot2c_f32_bf16 v74, s94, v175
 v_dot2c_f32_bf16 v75, v175, v175
 s_waitcnt vmcnt(8) lgkmcnt(0)
 ds_read_b128 v[192:195], v82 offset:32768
 ds_read_b128 v[196:199], v83 offset:32768
 ds_read_b128 v[200:203], v84 offset:32768
 ds_read_b128 v[204:207], v85 offset:32768
 s_add_u32 m0, s16, 81024
 v_dot2c_f32_bf16 v72, s94, v176
 v_dot2c_f32_bf16 v73, v176, v176
 buffer_load_dwordx4 v76, s[40:43], s68 offen offset:896 nt lds
 v_dot2c_f32_bf16 v74, s94, v177
 v_dot2c_f32_bf16 v75, v177, v177
 v_dot2c_f32_bf16 v72, s94, v178
 v_dot2c_f32_bf16 v73, v178, v178
 v_dot2c_f32_bf16 v74, s94, v179
 v_dot2c_f32_bf16 v75, v179, v179
 s_add_u32 m0, s16, 82048
 v_dot2c_f32_bf16 v72, s94, v180
 v_dot2c_f32_bf16 v73, v180, v180
 buffer_load_dwordx4 v77, s[40:43], s70 offen offset:896 nt lds
 v_dot2c_f32_bf16 v74, s94, v181
 v_dot2c_f32_bf16 v75, v181, v181
 v_dot2c_f32_bf16 v72, s94, v182
 v_dot2c_f32_bf16 v73, v182, v182
 v_dot2c_f32_bf16 v74, s94, v183
 v_dot2c_f32_bf16 v75, v183, v183
 s_add_u32 m0, s16, 83072
 v_dot2c_f32_bf16 v72, s94, v184
 v_dot2c_f32_bf16 v73, v184, v184
 buffer_load_dwordx4 v76, s[40:43], s72 offen offset:896 nt lds
 v_dot2c_f32_bf16 v74, s94, v185
 v_dot2c_f32_bf16 v75, v185, v185
 v_dot2c_f32_bf16 v72, s94, v186
 v_dot2c_f32_bf16 v73, v186, v186
 v_dot2c_f32_bf16 v74, s94, v187
 v_dot2c_f32_bf16 v75, v187, v187
 s_add_u32 m0, s16, 84096
 v_dot2c_f32_bf16 v72, s94, v188
 v_dot2c_f32_bf16 v73, v188, v188
 buffer_load_dwordx4 v77, s[40:43], s74 offen offset:896 nt lds
 v_mov_b32 v18, 1
 s_mov_b64 exec, 1
 ds_write_b32 v13, v18
 s_mov_b64 exec, -1
 v_dot2c_f32_bf16 v74, s94, v189
 v_dot2c_f32_bf16 v75, v189, v189
 v_dot2c_f32_bf16 v72, s94, v190
 v_dot2c_f32_bf16 v73, v190, v190
 v_dot2c_f32_bf16 v74, s94, v191
 v_dot2c_f32_bf16 v75, v191, v191
 s_waitcnt vmcnt(8) lgkmcnt(0)
 ds_read_b128 v[208:211], v82 offset:49152
 ds_read_b128 v[212:215], v83 offset:49152
 ds_read_b128 v[216:219], v84 offset:49152
 ds_read_b128 v[220:223], v85 offset:49152
 v_dot2c_f32_bf16 v72, s94, v192
 v_dot2c_f32_bf16 v73, v192, v192
 v_dot2c_f32_bf16 v74, s94, v193
 v_dot2c_f32_bf16 v75, v193, v193
 v_dot2c_f32_bf16 v72, s94, v194
 v_dot2c_f32_bf16 v73, v194, v194
 v_dot2c_f32_bf16 v74, s94, v195
 v_dot2c_f32_bf16 v75, v195, v195
 v_dot2c_f32_bf16 v72, s94, v196
 v_dot2c_f32_bf16 v73, v196, v196
 v_dot2c_f32_bf16 v74, s94, v197
 v_dot2c_f32_bf16 v75, v197, v197
 v_dot2c_f32_bf16 v72, s94, v198
 v_dot2c_f32_bf16 v73, v198, v198
 v_dot2c_f32_bf16 v74, s94, v199
 v_dot2c_f32_bf16 v75, v199, v199
 v_dot2c_f32_bf16 v72, s94, v200
 v_dot2c_f32_bf16 v73, v200, v200
 v_dot2c_f32_bf16 v74, s94, v201
 v_dot2c_f32_bf16 v75, v201, v201
 v_dot2c_f32_bf16 v72, s94, v202
 v_dot2c_f32_bf16 v73, v202, v202
 v_dot2c_f32_bf16 v74, s94, v203
 v_dot2c_f32_bf16 v75, v203, v203
 v_dot2c_f32_bf16 v72, s94, v204
 v_dot2c_f32_bf16 v73, v204, v204
 v_dot2c_f32_bf16 v74, s94, v205
 v_dot2c_f32_bf16 v75, v205, v205
 v_dot2c_f32_bf16 v72, s94, v206
 v_dot2c_f32_bf16 v73, v206, v206
 v_dot2c_f32_bf16 v74, s94, v207
 v_dot2c_f32_bf16 v75, v207, v207
 s_waitcnt vmcnt(4) lgkmcnt(0)
 ds_read_b128 v[224:227], v82 offset:0
 ds_read_b128 v[228:231], v83 offset:0
 ds_read_b128 v[232:235], v84 offset:0
 ds_read_b128 v[236:239], v85 offset:0
 v_dot2c_f32_bf16 v72, s94, v208
 v_dot2c_f32_bf16 v73, v208, v208
 v_dot2c_f32_bf16 v74, s94, v209
 v_dot2c_f32_bf16 v75, v209, v209
 v_dot2c_f32_bf16 v72, s94, v210
 v_dot2c_f32_bf16 v73, v210, v210
 v_dot2c_f32_bf16 v74, s94, v211
 v_dot2c_f32_bf16 v75, v211, v211
 v_dot2c_f32_bf16 v72, s94, v212
 v_dot2c_f32_bf16 v73, v212, v212
 v_dot2c_f32_bf16 v74, s94, v213
 v_dot2c_f32_bf16 v75, v213, v213
 v_dot2c_f32_bf16 v72, s94, v214
 v_dot2c_f32_bf16 v73, v214, v214
 v_dot2c_f32_bf16 v74, s94, v215
 v_dot2c_f32_bf16 v75, v215, v215
 v_dot2c_f32_bf16 v72, s94, v216
 v_dot2c_f32_bf16 v73, v216, v216
 v_dot2c_f32_bf16 v74, s94, v217
 v_dot2c_f32_bf16 v75, v217, v217
 v_dot2c_f32_bf16 v72, s94, v218
 v_dot2c_f32_bf16 v73, v218, v218
 v_dot2c_f32_bf16 v74, s94, v219
 v_dot2c_f32_bf16 v75, v219, v219
 v_dot2c_f32_bf16 v72, s94, v220
 v_dot2c_f32_bf16 v73, v220, v220
 v_dot2c_f32_bf16 v74, s94, v221
 v_dot2c_f32_bf16 v75, v221, v221
 v_dot2c_f32_bf16 v72, s94, v222
 v_dot2c_f32_bf16 v73, v222, v222
 v_dot2c_f32_bf16 v74, s94, v223
 v_dot2c_f32_bf16 v75, v223, v223
 s_waitcnt vmcnt(0) lgkmcnt(0)
 ds_read_b128 v[240:243], v82 offset:16384
 ds_read_b128 v[244:247], v83 offset:16384
 ds_read_b128 v[248:251], v84 offset:16384
 ds_read_b128 v[252:255], v85 offset:16384
 v_mov_b32 v18, 2
 s_mov_b64 exec, 1
 ds_write_b32 v13, v18
 s_mov_b64 exec, -1
 v_dot2c_f32_bf16 v72, s94, v224
 v_dot2c_f32_bf16 v73, v224, v224
 v_dot2c_f32_bf16 v74, s94, v225
 v_dot2c_f32_bf16 v75, v225, v225
 v_dot2c_f32_bf16 v72, s94, v226
 v_dot2c_f32_bf16 v73, v226, v226
 v_dot2c_f32_bf16 v74, s94, v227
 v_dot2c_f32_bf16 v75, v227, v227
 v_dot2c_f32_bf16 v72, s94, v228
 v_dot2c_f32_bf16 v73, v228, v228
 v_dot2c_f32_bf16 v74, s94, v229
 v_dot2c_f32_bf16 v75, v229, v229
 v_dot2c_f32_bf16 v72, s94, v230
Lhop1:
 s_cbranch_execz Lhop5
 v_dot2c_f32_bf16 v73, v230, v230
 v_dot2c_f32_bf16 v74, s94, v231
 v_dot2c_f32_bf16 v75, v231, v231
 v_dot2c_f32_bf16 v72, s94, v232
 v_dot2c_f32_bf16 v73, v232, v232
 v_dot2c_f32_bf16 v74, s94, v233
 v_dot2c_f32_bf16 v75, v233, v233
 v_dot2c_f32_bf16 v72, s94, v234
 v_dot2c_f32_bf16 v73, v234, v234
 v_dot2c_f32_bf16 v74, s94, v235
 v_dot2c_f32_bf16 v75, v235, v235
 v_dot2c_f32_bf16 v72, s94, v236
 v_dot2c_f32_bf16 v73, v236, v236
 v_dot2c_f32_bf16 v74, s94, v237
 v_dot2c_f32_bf16 v75, v237, v237
 v_dot2c_f32_bf16 v72, s94, v238
 v_dot2c_f32_bf16 v73, v238, v238
 v_dot2c_f32_bf16 v74, s94, v239
 v_dot2c_f32_bf16 v75, v239, v239
 s_waitcnt lgkmcnt(0)
 v_dot2c_f32_bf16 v72, s94, v240
 v_dot2c_f32_bf16 v73, v240, v240
 v_dot2c_f32_bf16 v74, s94, v241
 v_dot2c_f32_bf16 v75, v241, v241
 v_dot2c_f32_bf16 v72, s94, v242
 v_dot2c_f32_bf16 v73, v242, v242
 v_dot2c_f32_bf16 v74, s94, v243
 v_dot2c_f32_bf16 v75, v243, v243
 v_dot2c_f32_bf16 v72, s94, v244
 v_dot2c_f32_bf16 v73, v244, v244
 v_dot2c_f32_bf16 v74, s94, v245
 v_dot2c_f32_bf16 v75, v245, v245
 v_dot2c_f32_bf16 v72, s94, v246
 v_dot2c_f32_bf16 v73, v246, v246
 v_dot2c_f32_bf16 v74, s94, v247
 v_dot2c_f32_bf16 v75, v247, v247
 v_dot2c_f32_bf16 v72, s94, v248
 v_dot2c_f32_bf16 v73, v248, v248
 v_dot2c_f32_bf16 v74, s94, v249
 v_dot2c_f32_bf16 v75, v249, v249
 v_dot2c_f32_bf16 v72, s94, v250
 v_dot2c_f32_bf16 v73, v250, v250
 v_dot2c_f32_bf16 v74, s94, v251
 v_dot2c_f32_bf16 v75, v251, v251
 v_dot2c_f32_bf16 v72, s94, v252
 v_dot2c_f32_bf16 v73, v252, v252
 v_dot2c_f32_bf16 v74, s94, v253
 v_dot2c_f32_bf16 v75, v253, v253
 v_dot2c_f32_bf16 v72, s94, v254
 v_dot2c_f32_bf16 v73, v254, v254
 v_dot2c_f32_bf16 v74, s94, v255
 v_dot2c_f32_bf16 v75, v255, v255
 ds_read_b128 v[124:127], v12 offset:16
 s_waitcnt lgkmcnt(0)
 v_min3_u32 v124, v124, v125, v126
 v_min_u32 v124, v124, v127
 v_cmp_gt_u32_e64 vcc, 1, v124
Law1:
 s_cbranch_vccnz Lax2
 ds_read_b64_tr_b16 v[88:89], v2 offset:0
 ds_read_b64_tr_b16 v[90:91], v2 offset:1024
 ds_read_b64_tr_b16 v[92:93], v2 offset:512
 ds_read_b64_tr_b16 v[94:95], v2 offset:1536
 ds_read_b64_tr_b16 v[96:97], v2 offset:2048
 ds_read_b64_tr_b16 v[98:99], v2 offset:3072
 ds_read_b64_tr_b16 v[100:101], v2 offset:2560
 ds_read_b64_tr_b16 v[102:103], v2 offset:3584
 s_waitcnt lgkmcnt(6)
 v_mfma_f32_32x32x16_bf16 v[56:71], v[88:91], v[128:131], 0
 ds_read_b64_tr_b16 v[104:105], v2 offset:4096
 ds_read_b64_tr_b16 v[106:107], v2 offset:5120
 s_waitcnt lgkmcnt(6)
 v_mfma_f32_32x32x16_bf16 v[56:71], v[92:95], v[132:135], v[56:71]
 ds_read_b64_tr_b16 v[108:109], v2 offset:4608
 ds_read_b64_tr_b16 v[110:111], v2 offset:5632
 v_add_f32 v120, v72, v74
 s_waitcnt lgkmcnt(6)
 v_mfma_f32_32x32x16_bf16 v[56:71], v[96:99], v[136:139], v[56:71]
 ds_read_b64_tr_b16 v[88:89], v2 offset:6144
 ds_read_b64_tr_b16 v[90:91], v2 offset:7168
 v_add_f32 v121, v73, v75
 s_waitcnt lgkmcnt(6)
 v_mfma_f32_32x32x16_bf16 v[56:71], v[100:103], v[140:143], v[56:71]
 ds_read_b64_tr_b16 v[92:93], v2 offset:6656
 ds_read_b64_tr_b16 v[94:95], v2 offset:7680
 v_permlane32_swap_b32 v120, v121
 s_waitcnt lgkmcnt(6)
 v_mfma_f32_32x32x16_bf16 v[56:71], v[104:107], v[144:147], v[56:71]
 ds_read_b64_tr_b16 v[96:97], v2 offset:8192
 ds_read_b64_tr_b16 v[98:99], v2 offset:9216
 v_add_f32 v120, v120, v121
 s_waitcnt lgkmcnt(6)
 v_mfma_f32_32x32x16_bf16 v[56:71], v[108:111], v[148:151], v[56:71]
 ds_read_b64_tr_b16 v[100:101], v2 offset:8704
 ds_read_b64_tr_b16 v[102:103], v2 offset:9728
 v_mul_f32 v121, 0x3b000000, v120
 s_waitcnt lgkmcnt(6)
 v_mfma_f32_32x32x16_bf16 v[56:71], v[88:91], v[152:155], v[56:71]
 ds_read_b64_tr_b16 v[104:105], v2 offset:10240
 ds_read_b64_tr_b16 v[106:107], v2 offset:11264
 v_mul_f32 v120, 0x3b000000, v120
 s_waitcnt lgkmcnt(6)
 v_mfma_f32_32x32x16_bf16 v[56:71], v[92:95], v[156:159], v[56:71]
 ds_read_b64_tr_b16 v[108:109], v2 offset:10752
 ds_read_b64_tr_b16 v[110:111], v2 offset:11776
 v_permlane32_swap_b32 v120, v121
 s_waitcnt lgkmcnt(6)
 v_mfma_f32_32x32x16_bf16 v[56:71], v[96:99], v[160:163], v[56:71]
 ds_read_b128 v[124:127], v12 offset:16
 ds_read_b64_tr_b16 v[88:89], v2 offset:12288
 ds_read_b64_tr_b16 v[90:91], v2 offset:13312
 v_fma_f32 v121, -v120, v120, v121
 s_waitcnt lgkmcnt(7)
 v_mfma_f32_32x32x16_bf16 v[56:71], v[100:103], v[164:167], v[56:71]
 ds_read_b64_tr_b16 v[92:93], v2 offset:12800
 ds_read_b64_tr_b16 v[94:95], v2 offset:13824
 v_max_f32_e64 v121, 0, v121
 s_waitcnt lgkmcnt(7)
 v_mfma_f32_32x32x16_bf16 v[56:71], v[104:107], v[168:171], v[56:71]
 ds_read_b64_tr_b16 v[96:97], v2 offset:14336
 ds_read_b64_tr_b16 v[98:99], v2 offset:15360
 v_add_f32 v121, 0x3727c5ac, v121
 s_waitcnt lgkmcnt(7)
 v_mfma_f32_32x32x16_bf16 v[56:71], v[108:111], v[172:175], v[56:71]
 ds_read_b64_tr_b16 v[100:101], v2 offset:14848
 ds_read_b64_tr_b16 v[102:103], v2 offset:15872
 s_waitcnt lgkmcnt(8)
 v_min3_u32 v124, v124, v125, v126
 v_min_u32 v124, v124, v127
 v_cmp_gt_u32 vcc, 2, v124
 v_rsq_f32 v17, v121
 s_waitcnt lgkmcnt(6)
 v_mfma_f32_32x32x16_bf16 v[56:71], v[88:91], v[176:179], v[56:71]
Law3:
 s_cbranch_vccnz Lax4
 ds_read_b64_tr_b16 v[104:105], v15 offset:0
 ds_read_b64_tr_b16 v[106:107], v15 offset:1024
 v_cvt_pk_bf16_f32 v122, -v120, -v120
 s_waitcnt lgkmcnt(6)
 v_mfma_f32_32x32x16_bf16 v[56:71], v[92:95], v[180:183], v[56:71]
 ds_read_b64_tr_b16 v[108:109], v15 offset:512
 ds_read_b64_tr_b16 v[110:111], v15 offset:1536
 v_mul_f32 v16, 0x3fb8aa3b, v17
 s_waitcnt lgkmcnt(6)
 v_mfma_f32_32x32x16_bf16 v[56:71], v[96:99], v[184:187], v[56:71]
 ds_read_b64_tr_b16 v[88:89], v15 offset:2048
 ds_read_b64_tr_b16 v[90:91], v15 offset:3072
 v_lshlrev_b32_e64 v123, 16, v122
 s_waitcnt lgkmcnt(6)
 v_mfma_f32_32x32x16_bf16 v[56:71], v[100:103], v[188:191], v[56:71]
 ds_read_b64_tr_b16 v[92:93], v15 offset:2560
 ds_read_b64_tr_b16 v[94:95], v15 offset:3584
 v_add_f32 v123, v120, v123
 s_waitcnt lgkmcnt(6)
 v_mfma_f32_16x16x32_bf16 v[116:119], v[112:115], v[104:107], 0
 ds_read_b64_tr_b16 v[96:97], v15 offset:4096
 ds_read_b64_tr_b16 v[98:99], v15 offset:5120
 v_cvt_pk_bf16_f32 v123, -v123, -v123
 s_waitcnt lgkmcnt(6)
 v_mfma_f32_16x16x32_bf16 v[116:119], v[112:115], v[108:111], v[116:119]
 ds_read_b64_tr_b16 v[100:101], v15 offset:4608
 ds_read_b64_tr_b16 v[102:103], v15 offset:5632
 v_cndmask_b32 v22, v122, v123, s[86:87]
 s_waitcnt lgkmcnt(6)
 v_mfma_f32_16x16x32_bf16 v[116:119], v[112:115], v[88:91], v[116:119]
 ds_read_b64_tr_b16 v[104:105], v15 offset:6144
 ds_read_b64_tr_b16 v[106:107], v15 offset:7168
 s_waitcnt lgkmcnt(6)
 v_mfma_f32_16x16x32_bf16 v[116:119], v[112:115], v[92:95], v[116:119]
 ds_read_b64_tr_b16 v[108:109], v15 offset:6656
 ds_read_b64_tr_b16 v[110:111], v15 offset:7680
 s_waitcnt lgkmcnt(6)
 v_mfma_f32_16x16x32_bf16 v[116:119], v[112:115], v[96:99], v[116:119]
 ds_read_b64_tr_b16 v[88:89], v2 offset:16384
 ds_read_b64_tr_b16 v[90:91], v2 offset:17408
 s_waitcnt lgkmcnt(6)
 v_mfma_f32_16x16x32_bf16 v[116:119], v[112:115], v[100:103], v[116:119]
 ds_read_b64_tr_b16 v[92:93], v2 offset:16896
 ds_read_b64_tr_b16 v[94:95], v2 offset:17920
 s_waitcnt lgkmcnt(6)
 v_mfma_f32_16x16x32_bf16 v[116:119], v[112:115], v[104:107], v[116:119]
 ds_read_b64_tr_b16 v[96:97], v2 offset:18432
 ds_read_b64_tr_b16 v[98:99], v2 offset:19456
 s_waitcnt lgkmcnt(6)
 v_mfma_f32_16x16x32_bf16 v[116:119], v[112:115], v[108:111], v[116:119]
 ds_read_b64_tr_b16 v[100:101], v2 offset:18944
 ds_read_b64_tr_b16 v[102:103], v2 offset:19968
 s_waitcnt lgkmcnt(6)
 v_mfma_f32_32x32x16_bf16 v[56:71], v[88:91], v[192:195], v[56:71]
 ds_read_b64_tr_b16 v[104:105], v2 offset:20480
 ds_read_b64_tr_b16 v[106:107], v2 offset:21504
 s_waitcnt lgkmcnt(6)
 v_mfma_f32_32x32x16_bf16 v[56:71], v[92:95], v[196:199], v[56:71]
 ds_read_b64_tr_b16 v[108:109], v2 offset:20992
 ds_read_b64_tr_b16 v[110:111], v2 offset:22016
 ds_write_b32 v6, v116 offset:0
 s_waitcnt lgkmcnt(7)
 v_mfma_f32_32x32x16_bf16 v[56:71], v[96:99], v[200:203], v[56:71]
 ds_read_b64_tr_b16 v[88:89], v2 offset:22528
 ds_read_b64_tr_b16 v[90:91], v2 offset:23552
 s_waitcnt lgkmcnt(7)
 v_mfma_f32_32x32x16_bf16 v[56:71], v[100:103], v[204:207], v[56:71]
 ds_read_b64_tr_b16 v[92:93], v2 offset:23040
 ds_read_b64_tr_b16 v[94:95], v2 offset:24064
 s_waitcnt lgkmcnt(7)
 v_mfma_f32_32x32x16_bf16 v[56:71], v[104:107], v[208:211], v[56:71]
 ds_read_b64_tr_b16 v[96:97], v2 offset:24576
 ds_read_b64_tr_b16 v[98:99], v2 offset:25600
 s_waitcnt lgkmcnt(7)
 v_mfma_f32_32x32x16_bf16 v[56:71], v[108:111], v[212:215], v[56:71]
 ds_read_b64_tr_b16 v[100:101], v2 offset:25088
 ds_read_b64_tr_b16 v[102:103], v2 offset:26112
 s_waitcnt lgkmcnt(6)
 v_mfma_f32_32x32x16_bf16 v[56:71], v[88:91], v[216:219], v[56:71]
 ds_read_b64_tr_b16 v[104:105], v2 offset:26624
 ds_read_b64_tr_b16 v[106:107], v2 offset:27648
 s_waitcnt lgkmcnt(6)
 v_mfma_f32_32x32x16_bf16 v[56:71], v[92:95], v[220:223], v[56:71]
 ds_read_b64_tr_b16 v[108:109], v2 offset:27136
 ds_read_b64_tr_b16 v[110:111], v2 offset:28160
 s_waitcnt lgkmcnt(6)
 v_mfma_f32_32x32x16_bf16 v[56:71], v[96:99], v[224:227], v[56:71]
 ds_read_b128 v[124:127], v12 offset:16
 ds_read_b64_tr_b16 v[88:89], v2 offset:28672
 ds_read_b64_tr_b16 v[90:91], v2 offset:29696
 s_waitcnt lgkmcnt(7)
 v_mfma_f32_32x32x16_bf16 v[56:71], v[100:103], v[228:231], v[56:71]
 ds_read_b64_tr_b16 v[92:93], v2 offset:29184
 ds_read_b64_tr_b16 v[94:95], v2 offset:30208
 s_waitcnt lgkmcnt(7)
 v_mfma_f32_32x32x16_bf16 v[56:71], v[104:107], v[232:235], v[56:71]
 ds_read_b64_tr_b16 v[96:97], v2 offset:30720
 ds_read_b64_tr_b16 v[98:99], v2 offset:31744
 s_waitcnt lgkmcnt(7)
 v_mfma_f32_32x32x16_bf16 v[56:71], v[108:111], v[236:239], v[56:71]
 ds_read_b64_tr_b16 v[100:101], v2 offset:31232
 ds_read_b64_tr_b16 v[102:103], v2 offset:32256
 s_waitcnt lgkmcnt(8)
 v_min3_u32 v124, v124, v125, v126
 v_min_u32 v124, v124, v127
 v_cmp_gt_u32_e64 vcc, 3, v124
 s_waitcnt lgkmcnt(6)
 v_mfma_f32_32x32x16_bf16 v[56:71], v[88:91], v[240:243], v[56:71]
Law5:
 s_cbranch_vccnz Lax6
 ds_read_b64_tr_b16 v[104:105], v2 offset:32768
 ds_read_b64_tr_b16 v[106:107], v2 offset:33792
 s_waitcnt lgkmcnt(6)
 v_mfma_f32_32x32x16_bf16 v[56:71], v[92:95], v[244:247], v[56:71]
 ds_read_b64_tr_b16 v[108:109], v2 offset:33280
 ds_read_b64_tr_b16 v[110:111], v2 offset:34304
 s_waitcnt lgkmcnt(6)
 v_mfma_f32_32x32x16_bf16 v[56:71], v[96:99], v[248:251], v[56:71]
 ds_read_b64_tr_b16 v[88:89], v2 offset:34816
 ds_read_b64_tr_b16 v[90:91], v2 offset:35840
 s_waitcnt lgkmcnt(6)
 v_mfma_f32_32x32x16_bf16 v[56:71], v[100:103], v[252:255], v[56:71]
 ds_read_b64_tr_b16 v[92:93], v2 offset:35328
 ds_read_b64_tr_b16 v[94:95], v2 offset:36352
 s_waitcnt lgkmcnt(6)
 v_mfma_f32_32x32x16_bf16 v[72:87], v[104:107], v[128:131], 0
 ds_read_b64_tr_b16 v[96:97], v2 offset:36864
 ds_read_b64_tr_b16 v[98:99], v2 offset:37888
 s_mov_b64 exec, 1
 ds_add_u32 v14, v14 offset:31232
 s_mov_b64 exec, -1
 s_waitcnt lgkmcnt(7)
 v_mfma_f32_32x32x16_bf16 v[72:87], v[108:111], v[132:135], v[72:87]
 ds_read_b64_tr_b16 v[100:101], v2 offset:37376
 ds_read_b64_tr_b16 v[102:103], v2 offset:38400
 s_waitcnt lgkmcnt(7)
 v_mfma_f32_32x32x16_bf16 v[72:87], v[88:91], v[136:139], v[72:87]
 ds_read_b64_tr_b16 v[104:105], v2 offset:38912
 ds_read_b64_tr_b16 v[106:107], v2 offset:39936
 s_waitcnt lgkmcnt(7)
 v_mfma_f32_32x32x16_bf16 v[72:87], v[92:95], v[140:143], v[72:87]
 ds_read_b64_tr_b16 v[108:109], v2 offset:39424
 ds_read_b64_tr_b16 v[110:111], v2 offset:40448
 s_waitcnt lgkmcnt(7)
 v_mfma_f32_32x32x16_bf16 v[72:87], v[96:99], v[144:147], v[72:87]
 ds_read_b64_tr_b16 v[88:89], v2 offset:40960
 ds_read_b64_tr_b16 v[90:91], v2 offset:41984
 s_waitcnt lgkmcnt(6)
 v_mfma_f32_32x32x16_bf16 v[72:87], v[100:103], v[148:151], v[72:87]
 ds_read_b64_tr_b16 v[92:93], v2 offset:41472
 ds_read_b64_tr_b16 v[94:95], v2 offset:42496
 s_waitcnt lgkmcnt(6)
 v_mfma_f32_32x32x16_bf16 v[72:87], v[104:107], v[152:155], v[72:87]
 ds_read_b64_tr_b16 v[96:97], v2 offset:43008
 ds_read_b64_tr_b16 v[98:99], v2 offset:44032
 s_waitcnt lgkmcnt(6)
 v_mfma_f32_32x32x16_bf16 v[72:87], v[108:111], v[156:159], v[72:87]
 ds_read_b64_tr_b16 v[100:101], v2 offset:43520
 ds_read_b64_tr_b16 v[102:103], v2 offset:44544
 s_waitcnt lgkmcnt(6)
 v_mfma_f32_32x32x16_bf16 v[72:87], v[88:91], v[160:163], v[72:87]
 ds_read_b128 v[124:127], v12 offset:16
 ds_read_b64_tr_b16 v[104:105], v2 offset:45056
 ds_read_b64_tr_b16 v[106:107], v2 offset:46080
 s_waitcnt lgkmcnt(7)
 v_mfma_f32_32x32x16_bf16 v[72:87], v[92:95], v[164:167], v[72:87]
 ds_read_b64_tr_b16 v[108:109], v2 offset:45568
 ds_read_b64_tr_b16 v[110:111], v2 offset:46592
 s_waitcnt lgkmcnt(7)
 v_mfma_f32_32x32x16_bf16 v[72:87], v[96:99], v[168:171], v[72:87]
 ds_read_b64_tr_b16 v[88:89], v2 offset:47104
 ds_read_b64_tr_b16 v[90:91], v2 offset:48128
 s_waitcnt lgkmcnt(7)
 v_mfma_f32_32x32x16_bf16 v[72:87], v[100:103], v[172:175], v[72:87]
 ds_read_b64_tr_b16 v[92:93], v2 offset:47616
 ds_read_b64_tr_b16 v[94:95], v2 offset:48640
 s_waitcnt lgkmcnt(8)
 v_min3_u32 v124, v124, v125, v126
 v_min_u32 v124, v124, v127
 v_cmp_gt_u32 vcc, 4, v124
 s_waitcnt lgkmcnt(6)
 v_mfma_f32_32x32x16_bf16 v[72:87], v[104:107], v[176:179], v[72:87]
Law7:
 s_cbranch_vccnz Lax8
 ds_read_b64_tr_b16 v[96:97], v15 offset:32768
 ds_read_b64_tr_b16 v[98:99], v15 offset:33792
Lhop2:
 s_cbranch_execz Lhop6
 s_waitcnt lgkmcnt(6)
 v_mfma_f32_32x32x16_bf16 v[72:87], v[108:111], v[180:183], v[72:87]
 ds_read_b64_tr_b16 v[100:101], v15 offset:33280
 ds_read_b64_tr_b16 v[102:103], v15 offset:34304
 s_waitcnt lgkmcnt(6)
 v_mfma_f32_32x32x16_bf16 v[72:87], v[88:91], v[184:187], v[72:87]
 ds_read_b64_tr_b16 v[104:105], v15 offset:34816
 ds_read_b64_tr_b16 v[106:107], v15 offset:35840
 s_waitcnt lgkmcnt(6)
 v_mfma_f32_32x32x16_bf16 v[72:87], v[92:95], v[188:191], v[72:87]
 ds_read_b64_tr_b16 v[108:109], v15 offset:35328
 ds_read_b64_tr_b16 v[110:111], v15 offset:36352
 s_waitcnt lgkmcnt(6)
 v_mfma_f32_16x16x32_bf16 v[116:119], v[112:115], v[96:99], 0
 ds_read_b64_tr_b16 v[88:89], v15 offset:36864
 ds_read_b64_tr_b16 v[90:91], v15 offset:37888
 s_waitcnt lgkmcnt(6)
 v_mfma_f32_16x16x32_bf16 v[116:119], v[112:115], v[100:103], v[116:119]
 ds_read_b64_tr_b16 v[92:93], v15 offset:37376
 ds_read_b64_tr_b16 v[94:95], v15 offset:38400
 s_waitcnt lgkmcnt(6)
 v_mfma_f32_16x16x32_bf16 v[116:119], v[112:115], v[104:107], v[116:119]
 ds_read_b64_tr_b16 v[96:97], v15 offset:38912
 ds_read_b64_tr_b16 v[98:99], v15 offset:39936
 s_waitcnt lgkmcnt(6)
 v_mfma_f32_16x16x32_bf16 v[116:119], v[112:115], v[108:111], v[116:119]
 ds_read_b64_tr_b16 v[100:101], v15 offset:39424
 ds_read_b64_tr_b16 v[102:103], v15 offset:40448
 s_waitcnt lgkmcnt(6)
 v_mfma_f32_16x16x32_bf16 v[116:119], v[112:115], v[88:91], v[116:119]
 ds_read_b64_tr_b16 v[104:105], v2 offset:49152
 ds_read_b64_tr_b16 v[106:107], v2 offset:50176
 s_waitcnt lgkmcnt(6)
 v_mfma_f32_16x16x32_bf16 v[116:119], v[112:115], v[92:95], v[116:119]
 ds_read_b64_tr_b16 v[108:109], v2 offset:49664
 ds_read_b64_tr_b16 v[110:111], v2 offset:50688
 s_waitcnt lgkmcnt(6)
 v_mfma_f32_16x16x32_bf16 v[116:119], v[112:115], v[96:99], v[116:119]
 ds_read_b64_tr_b16 v[88:89], v2 offset:51200
 ds_read_b64_tr_b16 v[90:91], v2 offset:52224
 s_waitcnt lgkmcnt(6)
 v_mfma_f32_16x16x32_bf16 v[116:119], v[112:115], v[100:103], v[116:119]
 ds_read_b64_tr_b16 v[92:93], v2 offset:51712
 ds_read_b64_tr_b16 v[94:95], v2 offset:52736
 s_waitcnt lgkmcnt(6)
 v_mfma_f32_32x32x16_bf16 v[72:87], v[104:107], v[192:195], v[72:87]
 ds_read_b64_tr_b16 v[96:97], v2 offset:53248
 ds_read_b64_tr_b16 v[98:99], v2 offset:54272
 s_waitcnt lgkmcnt(6)
 v_mfma_f32_32x32x16_bf16 v[72:87], v[108:111], v[196:199], v[72:87]
 ds_read_b64_tr_b16 v[100:101], v2 offset:53760
 ds_read_b64_tr_b16 v[102:103], v2 offset:54784
 ds_write_b32 v6, v116 offset:512
 v_mov_b32_e64 v18, 3
 s_mov_b64 exec, 1
 ds_write_b32 v13, v18
 s_mov_b64 exec, -1
 ds_read_b128 v[124:127], v12 offset:32
 v_and_b32 v112, 0x1f0, v1
 v_add_u32 v112, 159232, v112
 s_waitcnt lgkmcnt(9)
 v_mfma_f32_32x32x16_bf16 v[72:87], v[88:91], v[200:203], v[72:87]
 ds_read_b64_tr_b16 v[104:105], v2 offset:55296
 ds_read_b64_tr_b16 v[106:107], v2 offset:56320
 s_waitcnt lgkmcnt(9)
 v_mfma_f32_32x32x16_bf16 v[72:87], v[92:95], v[204:207], v[72:87]
 ds_read_b64_tr_b16 v[108:109], v2 offset:55808
 ds_read_b64_tr_b16 v[110:111], v2 offset:56832
 s_waitcnt lgkmcnt(9)
 v_mfma_f32_32x32x16_bf16 v[72:87], v[96:99], v[208:211], v[72:87]
 ds_read_b64_tr_b16 v[88:89], v2 offset:57344
 ds_read_b64_tr_b16 v[90:91], v2 offset:58368
 s_waitcnt lgkmcnt(6)
 v_min3_u32 v124, v124, v125, v126
 v_min_u32 v124, v124, v127
 v_cmp_gt_u32_e64 vcc, 3, v124
 v_mfma_f32_32x32x16_bf16 v[72:87], v[100:103], v[212:215], v[72:87]
 ds_read_b64_tr_b16 v[92:93], v2 offset:57856
 ds_read_b64_tr_b16 v[94:95], v2 offset:58880
Law9:
 s_cbranch_vccnz Lax10
 ds_read_b128 v[116:119], v112 offset:0
 ds_read_b128 v[120:123], v112 offset:512
 s_waitcnt lgkmcnt(8)
 v_mfma_f32_32x32x16_bf16 v[72:87], v[104:107], v[216:219], v[72:87]
 ds_read_b64_tr_b16 v[96:97], v2 offset:59392
 ds_read_b64_tr_b16 v[98:99], v2 offset:60416
 v_lshrrev_b32_e64 v124, 1, v2
 v_and_b32 v124, 0xf8, v124
 v_add_u32 v124, 157184, v124
 ds_read_b64_tr_b16 v[32:33], v124 offset:0
 ds_read_b64_tr_b16 v[34:35], v124 offset:256
 s_waitcnt lgkmcnt(10)
 v_mfma_f32_32x32x16_bf16 v[72:87], v[108:111], v[220:223], v[72:87]
 ds_read_b64_tr_b16 v[100:101], v2 offset:59904
 ds_read_b64_tr_b16 v[102:103], v2 offset:60928
 ds_read_b64_tr_b16 v[36:37], v124 offset:512
 ds_read_b64_tr_b16 v[38:39], v124 offset:768
 v_bfe_u32 v125, v1, 6, 1
 v_mul_u32_u24 v125, 0x8000, v125
 v_lshl_add_u32 v125, v125, 16, v125
 s_waitcnt lgkmcnt(12)
 v_mfma_f32_32x32x16_bf16 v[72:87], v[88:91], v[224:227], v[72:87]
 ds_read_b64_tr_b16 v[104:105], v2 offset:61440
 ds_read_b64_tr_b16 v[106:107], v2 offset:62464
 s_waitcnt lgkmcnt(10)
 v_add_f32 v116, v116, v117
 v_add_f32 v118, v118, v119
 v_add_f32 v116, v116, v118
 v_mfma_f32_32x32x16_bf16 v[72:87], v[92:95], v[228:231], v[72:87]
 ds_read_b64_tr_b16 v[108:109], v2 offset:61952
 ds_read_b64_tr_b16 v[110:111], v2 offset:62976
 v_cvt_pk_bf16_f32 v117, v116, v116
 v_lshlrev_b32 v117, 16, v117
 v_sub_f32 v117, v116, v117
 v_cvt_pk_bf16_f32 v26, v116, v117
 s_waitcnt lgkmcnt(10)
 v_mfma_f32_32x32x16_bf16 v[72:87], v[96:99], v[232:235], v[72:87]
 ds_read_b64_tr_b16 v[88:89], v2 offset:63488
 ds_read_b64_tr_b16 v[90:91], v2 offset:64512
 v_add_f32 v120, v120, v121
 v_add_f32_e64 v122, v122, v123
 v_mfma_f32_32x32x16_bf16 v[56:71], v[26:29], v[22:25], v[56:71]
 s_waitcnt lgkmcnt(8)
 v_mfma_f32_32x32x16_bf16 v[72:87], v[100:103], v[236:239], v[72:87]
 ds_read_b64_tr_b16 v[92:93], v2 offset:64000
 ds_read_b64_tr_b16 v[94:95], v2 offset:65024
 v_add_f32 v120, v120, v122
 v_cvt_pk_bf16_f32 v121, v120, v120
 v_lshlrev_b32 v121, 16, v121
 v_sub_f32_e64 v121, v120, v121
 s_waitcnt lgkmcnt(6)
 v_mfma_f32_32x32x16_bf16 v[72:87], v[104:107], v[240:243], v[72:87]
 v_cvt_pk_bf16_f32 v28, v120, v121
 v_xor_b32 v32, v125, v32
 s_waitcnt lgkmcnt(4)
 v_mfma_f32_32x32x16_bf16 v[72:87], v[108:111], v[244:247], v[72:87]
 v_xor_b32 v33, v125, v33
 v_xor_b32 v34, v125, v34
 v_xor_b32 v35, v125, v35
 v_xor_b32_e64 v36, v125, v36
 s_waitcnt lgkmcnt(2)
 v_mfma_f32_32x32x16_bf16 v[72:87], v[88:91], v[248:251], v[72:87]
 v_xor_b32 v37, v125, v37
 v_xor_b32 v38, v125, v38
 v_xor_b32 v39, v125, v39
 s_waitcnt lgkmcnt(0)
 v_mfma_f32_32x32x16_bf16 v[72:87], v[92:95], v[252:255], v[72:87]
 v_mfma_f32_32x32x16_bf16 v[72:87], v[28:31], v[22:25], v[72:87]
 s_branch Lent
.p2align 3
Ltop:
 s_xor_b32 s66, s66, 6656
 s_xor_b32 s17, s17, 3072
 v_and_b32 v228, 0x1f0, v1
 v_add_u32 v228, s66, v228
 s_barrier
 ds_read_b128 v[232:235], v228 offset:0
 ds_read_b128 v[236:239], v228 offset:512
 v_xor_b32 v2, 0x10000, v2
 v_xor_b32 v3, 0x10000, v3
 v_xor_b32 v4, 0x10000, v4
 v_mov_b64 v[40:41], v[56:57]
 v_mov_b64 v[42:43], v[58:59]
 v_mov_b64 v[44:45], v[60:61]
 v_mov_b64 v[46:47], v[62:63]
 v_mov_b64 v[48:49], v[64:65]
 v_mov_b64 v[50:51], v[66:67]
 v_mov_b64 v[52:53], v[68:69]
 v_mov_b64 v[54:55], v[70:71]
 s_waitcnt lgkmcnt(0)
 v_add_f32 v232, v232, v233
 v_add_f32 v234, v234, v235
 v_add_f32 v232, v232, v234
 v_cvt_pk_bf16_f32 v233, v232, v232
 v_lshlrev_b32 v233, 16, v233
 v_sub_f32 v233, v232, v233
 v_cvt_pk_bf16_f32 v26, v232, v233
 v_add_f32 v236, v236, v237
 v_add_f32 v238, v238, v239
 v_add_f32_e64 v236, v236, v238
 v_cvt_pk_bf16_f32 v237, v236, v236
 v_lshlrev_b32 v237, 16, v237
 v_sub_f32 v237, v236, v237
 v_cvt_pk_bf16_f32 v28, v236, v237
 buffer_load_dwordx4 v[248:251], v1, s[28:31], s76 offen offset:0 sc1
 ds_read_b64_tr_b16 v[88:89], v2 offset:0
 ds_read_b64_tr_b16 v[90:91], v2 offset:1024
 ds_read_b64_tr_b16 v[92:93], v2 offset:32768
 buffer_load_dwordx4 v[128:131], v1, s[36:39], s68 offen offset:0 sc1
 ds_read_b64_tr_b16 v[94:95], v2 offset:33792
 ds_read_b64_tr_b16 v[96:97], v2 offset:512
 buffer_load_dwordx4 v[132:135], v1, s[36:39], s68 offen offset:1024 sc1
 ds_read_b64_tr_b16 v[98:99], v2 offset:1536
 ds_read_b64_tr_b16 v[100:101], v2 offset:33280
 ds_read_b64_tr_b16 v[102:103], v2 offset:34304
 buffer_load_dwordx4 v[136:139], v1, s[36:39], s68 offen offset:2048 sc1
 ds_read_b64_tr_b16 v[104:105], v2 offset:2048
 ds_read_b64_tr_b16 v[106:107], v2 offset:3072
 buffer_load_dwordx4 v[140:143], v1, s[36:39], s68 offen offset:3072 sc1
 ds_read_b64_tr_b16 v[108:109], v2 offset:34816
 ds_read_b64_tr_b16 v[110:111], v2 offset:35840
Lxw12:
 s_waitcnt vmcnt(4) lgkmcnt(0)
 v_bitop3_b32 v124, v248, v249, s65 bitop3:0x7e
 v_bitop3_b32 v125, v250, v251, s65 bitop3:0x7e
 v_bitop3_b32 v124, v124, v125, 1 bitop3:0xa8
 v_cmp_ne_u32 vcc, 0, v124
 s_cbranch_vccnz Lxc11
 s_waitcnt vmcnt(3) lgkmcnt(0)
 v_mfma_f32_32x32x16_bf16 v[56:71], v[88:91], v[128:131], 0
 ds_read_b64_tr_b16 v[112:113], v2 offset:2560
 buffer_load_dwordx4 v[144:147], v1, s[36:39], s69 offen offset:0 sc1
 ds_read_b64_tr_b16 v[114:115], v2 offset:3584
 v_lshlrev_b32_e64 v252, 16, v248
 v_mfma_f32_32x32x16_bf16 v[72:87], v[92:95], v[128:131], 0
 ds_read_b64_tr_b16 v[116:117], v2 offset:35328
 buffer_load_dwordx4 v[148:151], v1, s[36:39], s69 offen offset:1024 sc1
 ds_read_b64_tr_b16 v[118:119], v2 offset:36352
 v_and_b32 v248, 0xffff0000, v248
 v_fmac_f32 v248, v252, v252
 v_lshlrev_b32_e64 v253, 16, v249
 s_waitcnt vmcnt(4) lgkmcnt(4)
 v_mfma_f32_32x32x16_bf16 v[56:71], v[96:99], v[132:135], v[56:71]
 ds_read_b64_tr_b16 v[88:89], v2 offset:4096
 buffer_load_dwordx4 v[152:155], v1, s[36:39], s69 offen offset:2048 sc1
 ds_read_b64_tr_b16 v[90:91], v2 offset:5120
 v_and_b32 v249, 0xffff0000, v249
 v_mfma_f32_32x32x16_bf16 v[72:87], v[100:103], v[132:135], v[72:87]
 ds_read_b64_tr_b16 v[92:93], v2 offset:36864
 buffer_load_dwordx4 v[156:159], v1, s[36:39], s69 offen offset:3072 sc1
 ds_read_b64_tr_b16 v[94:95], v2 offset:37888
 v_fmac_f32 v249, v253, v253
 v_lshlrev_b32 v254, 16, v250
 v_and_b32 v250, 0xffff0000, v250
 v_bitop3_b32 v18, v131, v135, s65 bitop3:0x7e
 s_waitcnt vmcnt(5) lgkmcnt(8)
 v_mfma_f32_32x32x16_bf16 v[56:71], v[104:107], v[136:139], v[56:71]
 ds_read_b64_tr_b16 v[96:97], v2 offset:4608
 buffer_load_dwordx4 v[160:163], v1, s[36:39], s70 offen offset:0 sc1
 ds_read_b64_tr_b16 v[98:99], v2 offset:5632
 v_fmac_f32 v250, v254, v254
 v_mfma_f32_32x32x16_bf16 v[72:87], v[108:111], v[136:139], v[72:87]
 ds_read_b64_tr_b16 v[100:101], v2 offset:37376
 ds_read_b64_tr_b16 v[102:103], v2 offset:38400
 v_lshlrev_b32_e64 v255, 16, v251
 v_and_b32 v251, 0xffff0000, v251
 v_bitop3_b32 v18, v139, v18, s65 bitop3:0xde
 s_waitcnt vmcnt(5) lgkmcnt(8)
 v_mfma_f32_32x32x16_bf16 v[56:71], v[112:115], v[140:143], v[56:71]
 ds_read_b64_tr_b16 v[104:105], v2 offset:6144
 buffer_load_dwordx4 v[164:167], v1, s[36:39], s70 offen offset:1024 sc1
 ds_read_b64_tr_b16 v[106:107], v2 offset:7168
 v_fmac_f32 v251, v255, v255
 v_mfma_f32_32x32x16_bf16 v[72:87], v[116:119], v[140:143], v[72:87]
 ds_read_b64_tr_b16 v[108:109], v2 offset:38912
 ds_read_b64_tr_b16 v[110:111], v2 offset:39936
 v_add_f32 v248, v248, v249
 v_add_f32 v250, v250, v251
 v_add_f32_e64 v252, v252, v253
 v_bitop3_b32 v18, v143, v18, s65 bitop3:0xde
 v_and_b32 v20, 1, v18
 v_cmp_ne_u32 vcc, 0, v20
 s_cbranch_vccnz Lrt13
 s_waitcnt vmcnt(5) lgkmcnt(8)
 v_mfma_f32_32x32x16_bf16 v[56:71], v[88:91], v[144:147], v[56:71]
 ds_read_b64_tr_b16 v[112:113], v2 offset:6656
 buffer_load_dwordx4 v[168:171], v1, s[36:39], s70 offen offset:2048 sc1
 ds_read_b64_tr_b16 v[114:115], v2 offset:7680
 v_add_f32_e64 v254, v254, v255
 v_mfma_f32_32x32x16_bf16 v[72:87], v[92:95], v[144:147], v[72:87]
 ds_read_b64_tr_b16 v[116:117], v2 offset:39424
 ds_read_b64_tr_b16 v[118:119], v2 offset:40448
 v_add_f32 v122, v252, v254
 v_add_f32 v123, v248, v250
 v_bitop3_b32 v18, v147, v18, s65 bitop3:0xde
 s_waitcnt vmcnt(5) lgkmcnt(8)
 v_mfma_f32_32x32x16_bf16 v[56:71], v[96:99], v[148:151], v[56:71]
 ds_read_b64_tr_b16 v[88:89], v2 offset:8192
 buffer_load_dwordx4 v[172:175], v1, s[36:39], s70 offen offset:3072 sc1
 ds_read_b64_tr_b16 v[90:91], v2 offset:9216
 s_nop 1
 v_mfma_f32_32x32x16_bf16 v[72:87], v[100:103], v[148:151], v[72:87]
 ds_read_b64_tr_b16 v[92:93], v2 offset:40960
 ds_read_b64_tr_b16 v[94:95], v2 offset:41984
 v_permlane32_swap_b32 v122, v123
 v_add_f32 v120, v122, v123
 v_add_f32_e64 v121, v122, v123
 v_bitop3_b32 v18, v151, v18, s65 bitop3:0xde
 s_waitcnt vmcnt(5) lgkmcnt(8)
 v_mfma_f32_32x32x16_bf16 v[56:71], v[104:107], v[152:155], v[56:71]
 ds_read_b64_tr_b16 v[96:97], v2 offset:8704
 buffer_load_dwordx4 v[176:179], v1, s[36:39], s71 offen offset:0 sc1
 ds_read_b64_tr_b16 v[98:99], v2 offset:9728
 s_nop 1
 v_mfma_f32_32x32x16_bf16 v[72:87], v[108:111], v[152:155], v[72:87]
 ds_read_b64_tr_b16 v[100:101], v2 offset:41472
 ds_read_b64_tr_b16 v[102:103], v2 offset:42496
 v_permlane32_swap_b32_e64 v120, v121
 v_mul_f32 v120, 0x3c800000, v120
 v_mul_f32 v121, 0x3b000000, v121
 v_bitop3_b32 v18, v155, v18, s65 bitop3:0xde
 s_waitcnt vmcnt(5) lgkmcnt(8)
 v_mfma_f32_32x32x16_bf16 v[56:71], v[112:115], v[156:159], v[56:71]
Lhop3:
 s_cbranch_execz Lhop7
 ds_read_b64_tr_b16 v[104:105], v2 offset:10240
 buffer_load_dwordx4 v[180:183], v1, s[36:39], s71 offen offset:1024 sc1
 ds_read_b64_tr_b16 v[106:107], v2 offset:11264
 v_fma_f32 v121, -v120, v120, v121
 v_mfma_f32_32x32x16_bf16 v[72:87], v[116:119], v[156:159], v[72:87]
 ds_read_b64_tr_b16 v[108:109], v2 offset:43008
 ds_read_b64_tr_b16 v[110:111], v2 offset:44032
 v_max_f32_e64 v121, 0, v121
 v_add_f32 v121, 0x3727c5ac, v121
 v_bitop3_b32 v18, v159, v18, s65 bitop3:0xde
 s_waitcnt vmcnt(5) lgkmcnt(8)
 v_mfma_f32_32x32x16_bf16 v[56:71], v[88:91], v[160:163], v[56:71]
 ds_read_b64_tr_b16 v[112:113], v2 offset:10752
 buffer_load_dwordx4 v[184:187], v1, s[36:39], s71 offen offset:2048 sc1
 ds_read_b64_tr_b16 v[114:115], v2 offset:11776
 v_rsq_f32 v17, v121
 v_mfma_f32_32x32x16_bf16 v[72:87], v[92:95], v[160:163], v[72:87]
 ds_read_b64_tr_b16 v[116:117], v2 offset:43520
 ds_read_b64_tr_b16 v[118:119], v2 offset:44544
 v_cvt_pk_bf16_f32 v122, -v120, -v120
 v_mul_f32 v16, 0x3fb8aa3b, v17
 v_lshlrev_b32_e64 v123, 16, v122
 v_bitop3_b32 v18, v163, v18, s65 bitop3:0xde
 s_waitcnt vmcnt(5) lgkmcnt(8)
 v_mfma_f32_32x32x16_bf16 v[56:71], v[96:99], v[164:167], v[56:71]
 ds_read_b64_tr_b16 v[88:89], v2 offset:12288
 buffer_load_dwordx4 v[188:191], v1, s[36:39], s71 offen offset:3072 sc1
 ds_read_b64_tr_b16 v[90:91], v2 offset:13312
 v_add_f32 v123, v120, v123
 v_mfma_f32_32x32x16_bf16 v[72:87], v[100:103], v[164:167], v[72:87]
 ds_read_b64_tr_b16 v[92:93], v2 offset:45056
 ds_read_b64_tr_b16 v[94:95], v2 offset:46080
 v_cvt_pk_bf16_f32 v123, -v123, -v123
 v_cndmask_b32 v22, v122, v123, s[86:87]
 v_bitop3_b32 v18, v167, v18, s65 bitop3:0xde
 s_waitcnt vmcnt(5) lgkmcnt(8)
 v_mfma_f32_32x32x16_bf16 v[56:71], v[104:107], v[168:171], v[56:71]
 ds_read_b64_tr_b16 v[96:97], v2 offset:12800
 buffer_load_dwordx4 v[192:195], v1, s[36:39], s72 offen offset:0 sc1
 ds_read_b64_tr_b16 v[98:99], v2 offset:13824
 v_mfma_f32_32x32x16_bf16 v[72:87], v[108:111], v[168:171], v[72:87]
 ds_read_b64_tr_b16 v[100:101], v2 offset:45568
 ds_read_b64_tr_b16 v[102:103], v2 offset:46592
 v_bitop3_b32 v18, v171, v18, s65 bitop3:0xde
 v_mfma_f32_32x32x16_bf16 v[56:71], v[26:29], v[22:25], v[56:71]
 s_waitcnt vmcnt(5) lgkmcnt(8)
 v_mfma_f32_32x32x16_bf16 v[56:71], v[112:115], v[172:175], v[56:71]
 ds_read_b64_tr_b16 v[104:105], v2 offset:14336
 buffer_load_dwordx4 v[196:199], v1, s[36:39], s72 offen offset:1024 sc1
 ds_read_b64_tr_b16 v[106:107], v2 offset:15360
 v_mfma_f32_32x32x16_bf16 v[72:87], v[116:119], v[172:175], v[72:87]
 ds_read_b64_tr_b16 v[108:109], v2 offset:47104
 ds_read_b64_tr_b16 v[110:111], v2 offset:48128
 v_bitop3_b32 v18, v175, v18, s65 bitop3:0xde
 s_waitcnt vmcnt(5) lgkmcnt(8)
 v_mfma_f32_32x32x16_bf16 v[56:71], v[88:91], v[176:179], v[56:71]
 ds_read_b64_tr_b16 v[112:113], v2 offset:14848
 buffer_load_dwordx4 v[200:203], v1, s[36:39], s72 offen offset:2048 sc1
 ds_read_b64_tr_b16 v[114:115], v2 offset:15872
 v_mfma_f32_32x32x16_bf16 v[72:87], v[92:95], v[176:179], v[72:87]
 ds_read_b64_tr_b16 v[116:117], v2 offset:47616
 ds_read_b64_tr_b16 v[118:119], v2 offset:48640
 v_bitop3_b32 v18, v179, v18, s65 bitop3:0xde
 v_mfma_f32_32x32x16_bf16 v[72:87], v[28:31], v[22:25], v[72:87]
 s_waitcnt vmcnt(5) lgkmcnt(8)
 v_mfma_f32_32x32x16_bf16 v[56:71], v[96:99], v[180:183], v[56:71]
 ds_read_b64_tr_b16 v[88:89], v2 offset:16384
 buffer_load_dwordx4 v[204:207], v1, s[36:39], s72 offen offset:3072 sc1
 ds_read_b64_tr_b16 v[90:91], v2 offset:17408
 v_mfma_f32_32x32x16_bf16 v[72:87], v[100:103], v[180:183], v[72:87]
 ds_read_b64_tr_b16 v[92:93], v2 offset:49152
 ds_read_b64_tr_b16 v[94:95], v2 offset:50176
 v_bitop3_b32 v18, v183, v18, s65 bitop3:0xde
 s_waitcnt vmcnt(5) lgkmcnt(8)
 v_mfma_f32_32x32x16_bf16 v[56:71], v[104:107], v[184:187], v[56:71]
 ds_read_b64_tr_b16 v[96:97], v2 offset:16896
 buffer_load_dwordx4 v[208:211], v1, s[36:39], s73 offen offset:0 sc1
 ds_read_b64_tr_b16 v[98:99], v2 offset:17920
 v_mfma_f32_32x32x16_bf16 v[72:87], v[108:111], v[184:187], v[72:87]
 ds_read_b64_tr_b16 v[100:101], v2 offset:49664
 ds_read_b64_tr_b16 v[102:103], v2 offset:50688
 v_bitop3_b32 v18, v187, v18, s65 bitop3:0xde
 s_waitcnt vmcnt(5) lgkmcnt(8)
 v_mfma_f32_32x32x16_bf16 v[56:71], v[112:115], v[188:191], v[56:71]
 ds_read_b64_tr_b16 v[104:105], v2 offset:18432
 buffer_load_dwordx4 v[212:215], v1, s[36:39], s73 offen offset:1024 sc1
 ds_read_b64_tr_b16 v[106:107], v2 offset:19456
 v_mfma_f32_32x32x16_bf16 v[72:87], v[116:119], v[188:191], v[72:87]
 ds_read_b64_tr_b16 v[108:109], v2 offset:51200
 ds_read_b64_tr_b16 v[110:111], v2 offset:52224
 v_bitop3_b32 v18, v191, v18, s65 bitop3:0xde
 s_waitcnt vmcnt(5) lgkmcnt(8)
 v_mfma_f32_32x32x16_bf16 v[56:71], v[88:91], v[192:195], v[56:71]
 ds_read_b64_tr_b16 v[112:113], v2 offset:18944
 buffer_load_dwordx4 v[216:219], v1, s[36:39], s73 offen offset:2048 sc1
 ds_read_b64_tr_b16 v[114:115], v2 offset:19968
 v_mfma_f32_32x32x16_bf16 v[72:87], v[92:95], v[192:195], v[72:87]
 ds_read_b64_tr_b16 v[116:117], v2 offset:51712
 ds_read_b64_tr_b16 v[118:119], v2 offset:52736
 v_bitop3_b32 v18, v195, v18, s65 bitop3:0xde
 s_waitcnt vmcnt(5) lgkmcnt(8)
 v_mfma_f32_32x32x16_bf16 v[56:71], v[96:99], v[196:199], v[56:71]
 ds_read_b64_tr_b16 v[88:89], v2 offset:20480
 buffer_load_dwordx4 v[220:223], v1, s[36:39], s73 offen offset:3072 sc1
 ds_read_b64_tr_b16 v[90:91], v2 offset:21504
 v_mfma_f32_32x32x16_bf16 v[72:87], v[100:103], v[196:199], v[72:87]
 ds_read_b64_tr_b16 v[92:93], v2 offset:53248
 ds_read_b64_tr_b16 v[94:95], v2 offset:54272
 v_bitop3_b32 v18, v199, v18, s65 bitop3:0xde
 s_waitcnt vmcnt(5) lgkmcnt(8)
 v_mfma_f32_32x32x16_bf16 v[56:71], v[104:107], v[200:203], v[56:71]
 ds_read_b64_tr_b16 v[96:97], v2 offset:20992
 buffer_load_dwordx4 v[224:227], v1, s[36:39], s74 offen offset:0 sc1
 ds_read_b64_tr_b16 v[98:99], v2 offset:22016
 v_mfma_f32_32x32x16_bf16 v[72:87], v[108:111], v[200:203], v[72:87]
 ds_read_b64_tr_b16 v[100:101], v2 offset:53760
 ds_read_b64_tr_b16 v[102:103], v2 offset:54784
 v_bitop3_b32 v18, v203, v18, s65 bitop3:0xde
 s_waitcnt vmcnt(5) lgkmcnt(8)
 v_mfma_f32_32x32x16_bf16 v[56:71], v[112:115], v[204:207], v[56:71]
 ds_read_b64_tr_b16 v[104:105], v2 offset:22528
 buffer_load_dwordx4 v[228:231], v1, s[36:39], s74 offen offset:1024 sc1
 ds_read_b64_tr_b16 v[106:107], v2 offset:23552
 v_mfma_f32_32x32x16_bf16 v[72:87], v[116:119], v[204:207], v[72:87]
 ds_read_b64_tr_b16 v[108:109], v2 offset:55296
 ds_read_b64_tr_b16 v[110:111], v2 offset:56320
 v_bitop3_b32 v18, v207, v18, s65 bitop3:0xde
 s_waitcnt vmcnt(5) lgkmcnt(8)
 v_mfma_f32_32x32x16_bf16 v[56:71], v[88:91], v[208:211], v[56:71]
 ds_read_b64_tr_b16 v[112:113], v2 offset:23040
 buffer_load_dwordx4 v[232:235], v1, s[36:39], s74 offen offset:2048 sc1
 ds_read_b64_tr_b16 v[114:115], v2 offset:24064
 v_mfma_f32_32x32x16_bf16 v[72:87], v[92:95], v[208:211], v[72:87]
 ds_read_b64_tr_b16 v[116:117], v2 offset:55808
 ds_read_b64_tr_b16 v[118:119], v2 offset:56832
 v_bitop3_b32 v18, v211, v18, s65 bitop3:0xde
 s_waitcnt vmcnt(5) lgkmcnt(8)
 v_mfma_f32_32x32x16_bf16 v[56:71], v[96:99], v[212:215], v[56:71]
 ds_read_b64_tr_b16 v[88:89], v2 offset:24576
 buffer_load_dwordx4 v[236:239], v1, s[36:39], s74 offen offset:3072 sc1
 ds_read_b64_tr_b16 v[90:91], v2 offset:25600
 v_mfma_f32_32x32x16_bf16 v[72:87], v[100:103], v[212:215], v[72:87]
 ds_read_b64_tr_b16 v[92:93], v2 offset:57344
 ds_read_b64_tr_b16 v[94:95], v2 offset:58368
 v_bitop3_b32 v18, v215, v18, s65 bitop3:0xde
 s_waitcnt vmcnt(5) lgkmcnt(8)
 v_mfma_f32_32x32x16_bf16 v[56:71], v[104:107], v[216:219], v[56:71]
 ds_read_b64_tr_b16 v[96:97], v2 offset:25088
 buffer_load_dwordx4 v[240:243], v1, s[36:39], s75 offen offset:0 sc1
 ds_read_b64_tr_b16 v[98:99], v2 offset:26112
 v_mfma_f32_32x32x16_bf16 v[72:87], v[108:111], v[216:219], v[72:87]
 ds_read_b64_tr_b16 v[100:101], v2 offset:57856
 ds_read_b64_tr_b16 v[102:103], v2 offset:58880
 v_bitop3_b32 v18, v219, v18, s65 bitop3:0xde
 s_waitcnt vmcnt(5) lgkmcnt(8)
 v_mfma_f32_32x32x16_bf16 v[56:71], v[112:115], v[220:223], v[56:71]
 ds_read_b64_tr_b16 v[104:105], v2 offset:26624
 buffer_load_dwordx4 v[244:247], v1, s[36:39], s75 offen offset:1024 sc1
 ds_read_b64_tr_b16 v[106:107], v2 offset:27648
 v_mfma_f32_32x32x16_bf16 v[72:87], v[116:119], v[220:223], v[72:87]
 ds_read_b64_tr_b16 v[108:109], v2 offset:59392
 ds_read_b64_tr_b16 v[110:111], v2 offset:60416
 v_bitop3_b32 v18, v223, v18, s65 bitop3:0xde
 s_waitcnt vmcnt(5) lgkmcnt(8)
 v_mfma_f32_32x32x16_bf16 v[56:71], v[88:91], v[224:227], v[56:71]
 ds_read_b64_tr_b16 v[112:113], v2 offset:27136
 buffer_load_dwordx4 v[248:251], v1, s[36:39], s75 offen offset:2048 sc1
 ds_read_b64_tr_b16 v[114:115], v2 offset:28160
 v_mfma_f32_32x32x16_bf16 v[72:87], v[92:95], v[224:227], v[72:87]
 ds_read_b64_tr_b16 v[116:117], v2 offset:59904
 ds_read_b64_tr_b16 v[118:119], v2 offset:60928
 v_bitop3_b32 v18, v227, v18, s65 bitop3:0xde
 s_waitcnt vmcnt(5) lgkmcnt(8)
 v_mfma_f32_32x32x16_bf16 v[56:71], v[96:99], v[228:231], v[56:71]
 ds_read_b64_tr_b16 v[88:89], v2 offset:28672
 buffer_load_dwordx4 v[252:255], v1, s[36:39], s75 offen offset:3072 sc1
 ds_read_b64_tr_b16 v[90:91], v2 offset:29696
 v_mfma_f32_32x32x16_bf16 v[72:87], v[100:103], v[228:231], v[72:87]
 ds_read_b64_tr_b16 v[92:93], v2 offset:61440
 ds_read_b64_tr_b16 v[94:95], v2 offset:62464
 v_bitop3_b32 v18, v231, v18, s65 bitop3:0xde
 s_waitcnt vmcnt(5) lgkmcnt(8)
 v_mfma_f32_32x32x16_bf16 v[56:71], v[104:107], v[232:235], v[56:71]
 ds_read_b64_tr_b16 v[96:97], v2 offset:29184
 ds_read_b64_tr_b16 v[98:99], v2 offset:30208
 v_mfma_f32_32x32x16_bf16 v[72:87], v[108:111], v[232:235], v[72:87]
 ds_read_b64_tr_b16 v[100:101], v2 offset:61952
 ds_read_b64_tr_b16 v[102:103], v2 offset:62976
 v_bitop3_b32 v18, v235, v18, s65 bitop3:0xde
 s_waitcnt vmcnt(4) lgkmcnt(8)
 v_mfma_f32_32x32x16_bf16 v[56:71], v[112:115], v[236:239], v[56:71]
 ds_read_b64_tr_b16 v[104:105], v2 offset:30720
 ds_read_b64_tr_b16 v[106:107], v2 offset:31744
 v_bitop3_b32 v18, v239, v18, s65 bitop3:0xde
 v_and_b32 v20, 1, v18
 v_cmp_ne_u32 vcc, 0, v20
 v_mfma_f32_32x32x16_bf16 v[72:87], v[116:119], v[236:239], v[72:87]
 ds_read_b64_tr_b16 v[108:109], v2 offset:63488
 ds_read_b64_tr_b16 v[110:111], v2 offset:64512
 s_cbranch_vccnz Lrt14
 s_mov_b64 exec, 1
 ds_add_u32 v14, v14 offset:31232
 s_mov_b64 exec, -1
 s_waitcnt vmcnt(3) lgkmcnt(9)
 v_mfma_f32_32x32x16_bf16 v[56:71], v[88:91], v[240:243], v[56:71]
 ds_read_b64_tr_b16 v[112:113], v2 offset:31232
 ds_read_b64_tr_b16 v[114:115], v2 offset:32256
 v_mfma_f32_32x32x16_bf16 v[72:87], v[92:95], v[240:243], v[72:87]
 ds_read_b64_tr_b16 v[116:117], v2 offset:64000
 ds_read_b64_tr_b16 v[118:119], v2 offset:65024
 v_bitop3_b32 v18, v243, v18, s65 bitop3:0xde
 s_waitcnt vmcnt(2) lgkmcnt(9)
 v_mfma_f32_32x32x16_bf16 v[56:71], v[96:99], v[244:247], v[56:71]
 v_mfma_f32_32x32x16_bf16 v[72:87], v[100:103], v[244:247], v[72:87]
 v_bitop3_b32 v18, v247, v18, s65 bitop3:0xde
 s_waitcnt vmcnt(1) lgkmcnt(5)
 v_mfma_f32_32x32x16_bf16 v[56:71], v[104:107], v[248:251], v[56:71]
 v_mfma_f32_32x32x16_bf16 v[72:87], v[108:111], v[248:251], v[72:87]
 v_bitop3_b32 v18, v251, v18, s65 bitop3:0xde
 s_waitcnt vmcnt(0) lgkmcnt(0)
 v_mfma_f32_32x32x16_bf16 v[56:71], v[112:115], v[252:255], v[56:71]
 v_bitop3_b32 v18, v255, v18, s65 bitop3:0xde
 v_and_b32 v20, 1, v18
 v_cmp_ne_u32_e64 vcc, 0, v20
 s_cbranch_vccnz Lxb16
Lxa15:
 s_nop 1
 v_mfma_f32_32x32x16_bf16 v[72:87], v[116:119], v[252:255], v[72:87]
Lent:
 s_nop 4
 v_cvt_pk_bf16_f32 v120, v56, v57
 v_cvt_pk_bf16_f32 v121, v58, v59
 v_cvt_pk_bf16_f32 v122, v60, v61
 v_cvt_pk_bf16_f32 v123, v62, v63
 v_cvt_pk_bf16_f32 v124, v64, v65
 v_cvt_pk_bf16_f32 v125, v66, v67
 v_mfma_f32_32x32x16_bf16 v[88:103], v[32:35], v[120:123], 0
 v_cvt_pk_bf16_f32 v126, v68, v69
 v_cvt_pk_bf16_f32 v127, v70, v71
 v_mul_f32 v72, v72, v17
 v_mul_f32 v73, v73, v17
 v_mul_f32 v74, v74, v17
 v_mul_f32_e64 v75, v75, v17
 v_mfma_f32_32x32x16_bf16 v[104:119], v[36:39], v[124:127], 0
 v_mul_f32 v76, v76, v17
 v_mul_f32 v77, v77, v17
 v_mul_f32 v78, v78, v17
 v_mul_f32 v79, v79, v17
 v_mul_f32 v80, v80, v17
 v_mul_f32 v81, v81, v17
 v_max3_f32 v120, v88, v89, v90
 v_max3_f32 v121, v91, v92, v93
 v_max3_f32 v120, v94, v95, v120
 v_max3_f32 v121, v96, v97, v121
 v_max3_f32 v120, v98, v99, v120
 v_max3_f32 v121, v100, v101, v121
 v_max3_f32 v120, v102, v103, v120
 v_max_f32 v120, v120, v121
 v_mul_f32 v120, v120, v16
 v_pk_mul_f32 v[82:83], v[82:83], v[16:17] op_sel:[0,1] op_sel_hi:[1,1]
 v_pk_mul_f32 v[84:85], v[84:85], v[16:17] op_sel:[0,1] op_sel_hi:[1,1]
 v_pk_mul_f32 v[86:87], v[86:87], v[16:17] op_sel:[0,1] op_sel_hi:[1,1]
 v_cvt_pk_bf16_f32 v72, v72, v73
 v_cvt_pk_bf16_f32 v73, v74, v75
 v_cvt_pk_bf16_f32 v74, v76, v77
 v_cvt_pk_bf16_f32 v75, v78, v79
 v_cvt_pk_bf16_f32 v76, v80, v81
 v_cvt_pk_bf16_f32 v77, v82, v83
 v_cvt_pk_bf16_f32 v78, v84, v85
 v_cvt_pk_bf16_f32 v79, v86, v87
 v_pk_fma_f32 v[88:89], v[88:89], v[16:17], v[120:121] op_sel_hi:[1,0,0] neg_lo:[0,0,1] neg_hi:[0,0,1]
 v_pk_fma_f32 v[90:91], v[90:91], v[16:17], v[120:121] op_sel_hi:[1,0,0] neg_lo:[0,0,1] neg_hi:[0,0,1]
 v_pk_fma_f32 v[92:93], v[92:93], v[16:17], v[120:121] op_sel_hi:[1,0,0] neg_lo:[0,0,1] neg_hi:[0,0,1]
 v_pk_fma_f32 v[94:95], v[94:95], v[16:17], v[120:121] op_sel_hi:[1,0,0] neg_lo:[0,0,1] neg_hi:[0,0,1]
 v_pk_fma_f32 v[96:97], v[96:97], v[16:17], v[120:121] op_sel_hi:[1,0,0] neg_lo:[0,0,1] neg_hi:[0,0,1]
 v_pk_fma_f32 v[98:99], v[98:99], v[16:17], v[120:121] op_sel_hi:[1,0,0] neg_lo:[0,0,1] neg_hi:[0,0,1]
 v_pk_fma_f32 v[100:101], v[100:101], v[16:17], v[120:121] op_sel_hi:[1,0,0] neg_lo:[0,0,1] neg_hi:[0,0,1]
 v_pk_fma_f32 v[102:103], v[102:103], v[16:17], v[120:121] op_sel_hi:[1,0,0] neg_lo:[0,0,1] neg_hi:[0,0,1]
 v_exp_f32 v88, v88
 v_exp_f32 v89, v89
 v_exp_f32 v90, v90
 v_exp_f32 v91, v91
 v_exp_f32 v92, v92
 v_exp_f32 v93, v93
 v_exp_f32 v94, v94
 v_exp_f32 v95, v95
 v_exp_f32 v96, v96
 v_exp_f32 v97, v97
 v_exp_f32 v98, v98
 v_exp_f32 v99, v99
 v_exp_f32 v100, v100
 v_exp_f32 v101, v101
Lhop4:
 s_cbranch_execz Lhop8
 v_exp_f32 v102, v102
 v_exp_f32_e64 v103, v103
 v_pk_add_f32 v[124:125], v[88:89], v[90:91]
 v_pk_add_f32 v[124:125], v[124:125], v[92:93]
 v_pk_add_f32 v[124:125], v[124:125], v[94:95]
 v_pk_add_f32 v[124:125], v[124:125], v[96:97]
 v_pk_add_f32 v[124:125], v[124:125], v[98:99]
 v_pk_add_f32 v[124:125], v[124:125], v[100:101]
 v_pk_add_f32 v[124:125], v[124:125], v[102:103]
 v_add_f32 v124, v124, v125
 v_rcp_f32 v124, v124
 v_mov_b32_e64 v80, s94
 v_pk_mul_f32 v[88:89], v[88:89], v[124:125] op_sel_hi:[1,0]
 v_pk_mul_f32 v[90:91], v[90:91], v[124:125] op_sel_hi:[1,0]
 v_pk_mul_f32 v[92:93], v[92:93], v[124:125] op_sel_hi:[1,0]
 v_pk_mul_f32 v[94:95], v[94:95], v[124:125] op_sel_hi:[1,0]
 v_pk_mul_f32 v[96:97], v[96:97], v[124:125] op_sel_hi:[1,0]
 v_pk_mul_f32 v[98:99], v[98:99], v[124:125] op_sel_hi:[1,0]
 v_pk_mul_f32 v[100:101], v[100:101], v[124:125] op_sel_hi:[1,0]
 v_pk_mul_f32 v[102:103], v[102:103], v[124:125] op_sel_hi:[1,0]
 v_cvt_pk_bf16_f32 v56, v88, v89
 v_cvt_pk_bf16_f32 v57, v90, v91
 v_cvt_pk_bf16_f32 v58, v92, v93
 v_cvt_pk_bf16_f32 v59, v94, v95
 v_cvt_pk_bf16_f32 v60, v96, v97
 v_cvt_pk_bf16_f32 v61, v98, v99
 v_cvt_pk_bf16_f32 v62, v100, v101
 v_cvt_pk_bf16_f32 v63, v102, v103
 v_max3_f32 v122, v104, v105, v106
 v_max3_f32 v123, v107, v108, v109
 v_max3_f32 v122, v110, v111, v122
 v_max3_f32 v123, v112, v113, v123
 v_max3_f32 v122, v114, v115, v122
 v_max3_f32 v123, v116, v117, v123
 v_max3_f32 v122, v118, v119, v122
 v_max_f32 v122, v122, v123
 v_mul_f32 v122, v122, v16
 v_pk_fma_f32 v[104:105], v[104:105], v[16:17], v[122:123] op_sel_hi:[1,0,0] neg_lo:[0,0,1] neg_hi:[0,0,1]
 v_pk_fma_f32 v[106:107], v[106:107], v[16:17], v[122:123] op_sel_hi:[1,0,0] neg_lo:[0,0,1] neg_hi:[0,0,1]
 v_pk_fma_f32 v[108:109], v[108:109], v[16:17], v[122:123] op_sel_hi:[1,0,0] neg_lo:[0,0,1] neg_hi:[0,0,1]
 v_pk_fma_f32 v[110:111], v[110:111], v[16:17], v[122:123] op_sel_hi:[1,0,0] neg_lo:[0,0,1] neg_hi:[0,0,1]
 v_pk_fma_f32 v[112:113], v[112:113], v[16:17], v[122:123] op_sel_hi:[1,0,0] neg_lo:[0,0,1] neg_hi:[0,0,1]
 v_pk_fma_f32 v[114:115], v[114:115], v[16:17], v[122:123] op_sel_hi:[1,0,0] neg_lo:[0,0,1] neg_hi:[0,0,1]
 v_pk_fma_f32 v[116:117], v[116:117], v[16:17], v[122:123] op_sel_hi:[1,0,0] neg_lo:[0,0,1] neg_hi:[0,0,1]
 v_pk_fma_f32 v[118:119], v[118:119], v[16:17], v[122:123] op_sel_hi:[1,0,0] neg_lo:[0,0,1] neg_hi:[0,0,1]
 ds_write_b128 v9, v[72:75] offset:17408
 v_exp_f32 v104, v104
 v_exp_f32 v105, v105
 v_exp_f32 v106, v106
 v_exp_f32 v107, v107
 v_exp_f32 v108, v108
 v_exp_f32 v109, v109
 v_exp_f32 v110, v110
 v_exp_f32 v111, v111
 ds_write_b128 v9, v[76:79] offset:21760
 v_exp_f32 v112, v112
 v_exp_f32 v113, v113
 v_exp_f32 v114, v114
 v_exp_f32 v115, v115
 v_exp_f32 v116, v116
 v_exp_f32 v117, v117
 v_exp_f32 v118, v118
 v_exp_f32 v119, v119
 ds_write_b128 v8, v[56:59] offset:0
 v_pk_add_f32 v[126:127], v[104:105], v[106:107]
 v_pk_add_f32 v[126:127], v[126:127], v[108:109]
 v_pk_add_f32 v[126:127], v[126:127], v[110:111]
 v_pk_add_f32 v[126:127], v[126:127], v[112:113]
 v_pk_add_f32 v[126:127], v[126:127], v[114:115]
 v_pk_add_f32 v[126:127], v[126:127], v[116:117]
 v_pk_add_f32 v[126:127], v[126:127], v[118:119]
 v_add_f32 v126, v126, v127
 v_rcp_f32 v126, v126
 ds_write_b128 v8, v[60:63] offset:2176
 v_pk_mul_f32 v[104:105], v[104:105], v[126:127] op_sel_hi:[1,0]
 v_pk_mul_f32 v[106:107], v[106:107], v[126:127] op_sel_hi:[1,0]
 v_pk_mul_f32 v[108:109], v[108:109], v[126:127] op_sel_hi:[1,0]
 v_pk_mul_f32 v[110:111], v[110:111], v[126:127] op_sel_hi:[1,0]
 v_pk_mul_f32 v[112:113], v[112:113], v[126:127] op_sel_hi:[1,0]
 v_pk_mul_f32 v[114:115], v[114:115], v[126:127] op_sel_hi:[1,0]
 v_pk_mul_f32 v[116:117], v[116:117], v[126:127] op_sel_hi:[1,0]
 v_pk_mul_f32 v[118:119], v[118:119], v[126:127] op_sel_hi:[1,0]
 v_cvt_pk_bf16_f32 v64, v104, v105
 v_cvt_pk_bf16_f32 v65, v106, v107
 v_cvt_pk_bf16_f32 v66, v108, v109
 v_cvt_pk_bf16_f32 v67, v110, v111
 ds_write_b128 v8, v[64:67] offset:8704
 v_cvt_pk_bf16_f32 v68, v112, v113
 v_cvt_pk_bf16_f32 v69, v114, v115
 v_cvt_pk_bf16_f32 v70, v116, v117
 v_cvt_pk_bf16_f32 v71, v118, v119
 ds_write_b128 v8, v[68:71] offset:10880
 v_mov_b32 v81, s94
 v_mov_b32 v82, s94
 v_mov_b32_e64 v83, s94
 s_waitcnt lgkmcnt(0)
 s_barrier
 ds_read_b64_tr_b16 v[88:89], v10 offset:0
 ds_read_b64_tr_b16 v[90:91], v10 offset:256
 ds_read_b64_tr_b16 v[92:93], v11 offset:0
 ds_read_b64_tr_b16 v[94:95], v11 offset:256
 ds_read_b64_tr_b16 v[96:97], v10 offset:512
 ds_read_b64_tr_b16 v[98:99], v10 offset:768
 ds_read_b64_tr_b16 v[100:101], v11 offset:512
 ds_read_b64_tr_b16 v[102:103], v11 offset:768
 ds_read_b64_tr_b16 v[104:105], v10 offset:1024
 ds_read_b64_tr_b16 v[106:107], v10 offset:1280
 ds_read_b64_tr_b16 v[108:109], v11 offset:1024
 ds_read_b64_tr_b16 v[110:111], v11 offset:1280
 s_waitcnt lgkmcnt(8)
 v_mfma_f32_16x16x32_bf16 v[56:59], v[88:91], v[92:95], 0
 v_mfma_f32_16x16x32_bf16 v[60:63], v[88:91], v[80:83], 0
 ds_read_b64_tr_b16 v[112:113], v10 offset:1536
 ds_read_b64_tr_b16 v[114:115], v10 offset:1792
 ds_read_b64_tr_b16 v[116:117], v11 offset:1536
 ds_read_b64_tr_b16 v[118:119], v11 offset:1792
 s_waitcnt lgkmcnt(8)
 v_mfma_f32_16x16x32_bf16 v[60:63], v[96:99], v[80:83], v[60:63]
 v_mfma_f32_16x16x32_bf16 v[56:59], v[96:99], v[100:103], v[56:59]
 s_waitcnt lgkmcnt(4)
 v_mfma_f32_16x16x32_bf16 v[60:63], v[104:107], v[80:83], v[60:63]
 v_mfma_f32_16x16x32_bf16 v[56:59], v[104:107], v[108:111], v[56:59]
 s_waitcnt lgkmcnt(0)
 v_mfma_f32_16x16x32_bf16 v[60:63], v[112:115], v[80:83], v[60:63]
 v_mfma_f32_16x16x32_bf16 v[56:59], v[112:115], v[116:119], v[56:59]
 s_nop 6
 v_cvt_pk_bf16_f32 v126, v60, v61
 v_cvt_pk_bf16_f32 v127, v62, v63
 v_min_u32 v126, -2, v126
 buffer_store_dwordx2 v[126:127], v7, s[28:31], s7 offen sc1
 v_cvt_pk_bf16_f32 v124, v56, v57
 v_cvt_pk_bf16_f32 v125, v58, v59
 v_min_u32_e64 v124, -2, v124
 buffer_store_dwordx2 v[124:125], v27, s[28:31], s5 offen sc1
 s_barrier
 ds_read_b64_tr_b16 v[88:89], v3 offset:32768
 ds_read_b64_tr_b16 v[90:91], v3 offset:33792
 ds_read_b64_tr_b16 v[92:93], v3 offset:33280
 ds_read_b64_tr_b16 v[94:95], v3 offset:34304
 ds_read_b64_tr_b16 v[96:97], v3 offset:34816
 ds_read_b64_tr_b16 v[98:99], v3 offset:35840
 ds_read_b64_tr_b16 v[100:101], v3 offset:35328
 ds_read_b64_tr_b16 v[102:103], v3 offset:36352
 v_xor_b32 v12, 32, v4
 v_xor_b32_e64 v13, 64, v4
 v_xor_b32 v15, 96, v4
 v_mov_b32 v6, s65
 s_waitcnt lgkmcnt(6)
 v_mfma_f32_32x32x16_bf16 v[72:87], v[88:91], v[128:131], 0
 ds_read_b64_tr_b16 v[104:105], v3 offset:36864
 ds_read_b64_tr_b16 v[106:107], v3 offset:37888
 v_mov_b32 v57, 162316
 s_waitcnt lgkmcnt(6)
 v_mfma_f32_32x32x16_bf16 v[72:87], v[92:95], v[132:135], v[72:87]
 ds_read_b64_tr_b16 v[108:109], v3 offset:37376
 ds_read_b64_tr_b16 v[110:111], v3 offset:38400
 v_and_b32 v56, 0x1f0, v1
 s_waitcnt lgkmcnt(6)
 v_mfma_f32_32x32x16_bf16 v[72:87], v[96:99], v[136:139], v[72:87]
 ds_read_b64_tr_b16 v[112:113], v3 offset:38912
 ds_read_b64_tr_b16 v[114:115], v3 offset:39936
 v_add_u32 v56, s66, v56
 s_waitcnt lgkmcnt(6)
 v_mfma_f32_32x32x16_bf16 v[72:87], v[100:103], v[140:143], v[72:87]
 ds_read_b64_tr_b16 v[116:117], v3 offset:39424
 ds_read_b64_tr_b16 v[118:119], v3 offset:40448
 ds_read_b32 v57, v57
 ds_read_b128 v[60:63], v56 offset:1024
 s_waitcnt lgkmcnt(8)
 v_mfma_f32_32x32x16_bf16 v[72:87], v[104:107], v[144:147], v[72:87]
 ds_read_b64_tr_b16 v[88:89], v3 offset:40960
 ds_read_b64_tr_b16 v[90:91], v3 offset:41984
 s_add_u32 s5, s5, 655360
 s_waitcnt lgkmcnt(8)
 v_mfma_f32_32x32x16_bf16 v[72:87], v[108:111], v[148:151], v[72:87]
 ds_read_b64_tr_b16 v[92:93], v3 offset:41472
 ds_read_b64_tr_b16 v[94:95], v3 offset:42496
 s_add_u32 s7, s7, 655360
 s_waitcnt lgkmcnt(8)
 v_mfma_f32_32x32x16_bf16 v[72:87], v[112:115], v[152:155], v[72:87]
 ds_read_b64_tr_b16 v[96:97], v3 offset:43008
 ds_read_b64_tr_b16 v[98:99], v3 offset:44032
 ds_read_b64_tr_b16 v[128:129], v4 offset:0
 s_waitcnt lgkmcnt(9)
 v_mfma_f32_32x32x16_bf16 v[72:87], v[116:119], v[156:159], v[72:87]
 ds_read_b64_tr_b16 v[100:101], v3 offset:43520
 ds_read_b64_tr_b16 v[102:103], v3 offset:44544
 ds_read_b64_tr_b16 v[130:131], v4 offset:1024
 s_waitcnt lgkmcnt(8)
 v_mfma_f32_32x32x16_bf16 v[72:87], v[88:91], v[160:163], v[72:87]
 ds_read_b64_tr_b16 v[104:105], v3 offset:45056
 ds_read_b64_tr_b16 v[106:107], v3 offset:46080
 ds_read_b64_tr_b16 v[132:133], v12 offset:0
 s_waitcnt lgkmcnt(9)
 v_mfma_f32_32x32x16_bf16 v[72:87], v[92:95], v[164:167], v[72:87]
 ds_read_b64_tr_b16 v[108:109], v3 offset:45568
 ds_read_b64_tr_b16 v[110:111], v3 offset:46592
 ds_read_b64_tr_b16 v[134:135], v12 offset:1024
 s_waitcnt lgkmcnt(10)
 v_mfma_f32_32x32x16_bf16 v[72:87], v[96:99], v[168:171], v[72:87]
 ds_read_b64_tr_b16 v[112:113], v3 offset:47104
 ds_read_b64_tr_b16 v[114:115], v3 offset:48128
 v_readfirstlane_b32 s63, v57
 s_waitcnt lgkmcnt(9)
 v_mfma_f32_32x32x16_bf16 v[72:87], v[100:103], v[172:175], v[72:87]
 ds_read_b64_tr_b16 v[116:117], v3 offset:47616
 ds_read_b64_tr_b16 v[118:119], v3 offset:48640
 v_add_f32_e64 v60, v60, v61
 s_waitcnt lgkmcnt(8)
 v_mfma_f32_32x32x16_bf16 v[72:87], v[104:107], v[176:179], v[72:87]
 ds_read_b64_tr_b16 v[88:89], v3 offset:49152
 ds_read_b64_tr_b16 v[90:91], v3 offset:50176
 v_add_f32 v62, v62, v63
 s_waitcnt lgkmcnt(7)
 v_mfma_f32_32x32x16_bf16 v[72:87], v[108:111], v[180:183], v[72:87]
 ds_read_b64_tr_b16 v[92:93], v3 offset:49664
 ds_read_b64_tr_b16 v[94:95], v3 offset:50688
 v_add_f32 v60, v60, v62
 s_waitcnt lgkmcnt(6)
 v_mfma_f32_32x32x16_bf16 v[72:87], v[112:115], v[184:187], v[72:87]
 ds_read_b64_tr_b16 v[96:97], v3 offset:51200
 ds_read_b64_tr_b16 v[98:99], v3 offset:52224
 v_cvt_pk_bf16_f32 v61, v60, v60
 s_waitcnt lgkmcnt(6)
 v_mfma_f32_32x32x16_bf16 v[72:87], v[116:119], v[188:191], v[72:87]
 ds_read_b64_tr_b16 v[100:101], v3 offset:51712
 ds_read_b64_tr_b16 v[102:103], v3 offset:52736
 v_lshlrev_b32_e64 v61, 16, v61
 s_waitcnt lgkmcnt(6)
 v_mfma_f32_32x32x16_bf16 v[72:87], v[88:91], v[192:195], v[72:87]
 ds_read_b64_tr_b16 v[104:105], v3 offset:53248
 ds_read_b64_tr_b16 v[106:107], v3 offset:54272
 v_sub_f32 v61, v60, v61
 s_waitcnt lgkmcnt(6)
 v_mfma_f32_32x32x16_bf16 v[72:87], v[92:95], v[196:199], v[72:87]
 ds_read_b64_tr_b16 v[108:109], v3 offset:53760
 ds_read_b64_tr_b16 v[110:111], v3 offset:54784
 v_cvt_pk_bf16_f32 v30, v60, v61
 s_waitcnt lgkmcnt(6)
 v_mfma_f32_32x32x16_bf16 v[72:87], v[96:99], v[200:203], v[72:87]
 ds_read_b64_tr_b16 v[112:113], v3 offset:55296
 ds_read_b64_tr_b16 v[114:115], v3 offset:56320
 ds_read_b64_tr_b16 v[136:137], v13 offset:0
 s_waitcnt lgkmcnt(7)
 v_mfma_f32_32x32x16_bf16 v[72:87], v[100:103], v[204:207], v[72:87]
 ds_read_b64_tr_b16 v[116:117], v3 offset:55808
 ds_read_b64_tr_b16 v[118:119], v3 offset:56832
 ds_read_b64_tr_b16 v[138:139], v13 offset:1024
 s_waitcnt lgkmcnt(8)
 v_mfma_f32_32x32x16_bf16 v[72:87], v[104:107], v[208:211], v[72:87]
 ds_read_b64_tr_b16 v[88:89], v3 offset:57344
 ds_read_b64_tr_b16 v[90:91], v3 offset:58368
 ds_read_b64_tr_b16 v[140:141], v15 offset:0
 s_waitcnt lgkmcnt(9)
 v_mfma_f32_32x32x16_bf16 v[72:87], v[108:111], v[212:215], v[72:87]
 ds_read_b64_tr_b16 v[92:93], v3 offset:57856
 ds_read_b64_tr_b16 v[94:95], v3 offset:58880
 ds_read_b64_tr_b16 v[142:143], v15 offset:1024
 s_waitcnt lgkmcnt(10)
 v_mfma_f32_32x32x16_bf16 v[72:87], v[112:115], v[216:219], v[72:87]
 ds_read_b64_tr_b16 v[96:97], v3 offset:59392
 ds_read_b64_tr_b16 v[98:99], v3 offset:60416
 ds_read_b64_tr_b16 v[144:145], v4 offset:4096
 s_waitcnt lgkmcnt(10)
 v_mfma_f32_32x32x16_bf16 v[72:87], v[116:119], v[220:223], v[72:87]
 ds_read_b64_tr_b16 v[100:101], v3 offset:59904
 ds_read_b64_tr_b16 v[102:103], v3 offset:60928
 ds_read_b64_tr_b16 v[146:147], v4 offset:5120
 s_waitcnt lgkmcnt(10)
 v_mfma_f32_32x32x16_bf16 v[72:87], v[88:91], v[224:227], v[72:87]
 ds_read_b64_tr_b16 v[104:105], v3 offset:61440
 ds_read_b64_tr_b16 v[106:107], v3 offset:62464
 ds_read_b64_tr_b16 v[148:149], v12 offset:4096
 s_waitcnt lgkmcnt(10)
 v_mfma_f32_32x32x16_bf16 v[72:87], v[92:95], v[228:231], v[72:87]
 ds_read_b64_tr_b16 v[108:109], v3 offset:61952
 ds_read_b64_tr_b16 v[110:111], v3 offset:62976
 ds_read_b64_tr_b16 v[150:151], v12 offset:5120
 s_waitcnt lgkmcnt(10)
 v_mfma_f32_32x32x16_bf16 v[72:87], v[96:99], v[232:235], v[72:87]
 ds_read_b64_tr_b16 v[112:113], v3 offset:63488
 ds_read_b64_tr_b16 v[114:115], v3 offset:64512
 ds_read_b64_tr_b16 v[152:153], v13 offset:4096
 s_waitcnt lgkmcnt(10)
 v_mfma_f32_32x32x16_bf16 v[72:87], v[100:103], v[236:239], v[72:87]
Lhop5:
 s_cbranch_execz Lhop9
 ds_read_b64_tr_b16 v[116:117], v3 offset:64000
 ds_read_b64_tr_b16 v[118:119], v3 offset:65024
 ds_read_b64_tr_b16 v[154:155], v13 offset:5120
 s_waitcnt lgkmcnt(10)
 v_mfma_f32_32x32x16_bf16 v[72:87], v[104:107], v[240:243], v[72:87]
 ds_read_b64_tr_b16 v[156:157], v15 offset:4096
 ds_read_b64_tr_b16 v[158:159], v15 offset:5120
 ds_read_b64_tr_b16 v[160:161], v4 offset:8192
 s_waitcnt lgkmcnt(10)
 v_mfma_f32_32x32x16_bf16 v[72:87], v[108:111], v[244:247], v[72:87]
 ds_read_b64_tr_b16 v[162:163], v4 offset:9216
 ds_read_b64_tr_b16 v[164:165], v12 offset:8192
 ds_read_b64_tr_b16 v[166:167], v12 offset:9216
 s_waitcnt lgkmcnt(10)
 v_mfma_f32_32x32x16_bf16 v[72:87], v[112:115], v[248:251], v[72:87]
 ds_read_b64_tr_b16 v[168:169], v13 offset:8192
 ds_read_b64_tr_b16 v[170:171], v13 offset:9216
 ds_read_b64_tr_b16 v[172:173], v15 offset:8192
 s_waitcnt lgkmcnt(10)
 v_mfma_f32_32x32x16_bf16 v[72:87], v[116:119], v[252:255], v[72:87]
 ds_read_b64_tr_b16 v[174:175], v15 offset:9216
 ds_read_b64_tr_b16 v[176:177], v4 offset:12288
 ds_read_b64_tr_b16 v[178:179], v4 offset:13312
 v_mfma_f32_32x32x16_bf16 v[72:87], v[30:33], v[22:25], v[72:87]
 ds_read_b64_tr_b16 v[180:181], v12 offset:12288
 ds_read_b64_tr_b16 v[182:183], v12 offset:13312
 s_waitcnt lgkmcnt(11)
 ds_read_b64_tr_b16 v[184:185], v13 offset:12288
 ds_read_b64_tr_b16 v[186:187], v13 offset:13312
 ds_read_b64_tr_b16 v[188:189], v15 offset:12288
 ds_read_b64_tr_b16 v[190:191], v15 offset:13312
 s_nop 5
 v_cvt_pk_bf16_f32 v120, v72, v73
 v_cvt_pk_bf16_f32 v121, v74, v75
 v_cvt_pk_bf16_f32 v122, v76, v77
 v_cvt_pk_bf16_f32 v123, v78, v79
 v_cvt_pk_bf16_f32 v124, v80, v81
 v_cvt_pk_bf16_f32 v125, v82, v83
 v_mfma_f32_32x32x16_bf16 v[88:103], v[32:35], v[120:123], 0
 v_cvt_pk_bf16_f32 v126, v84, v85
 v_cvt_pk_bf16_f32 v127, v86, v87
 s_waitcnt lgkmcnt(11)
 ds_read_b64_tr_b16 v[192:193], v4 offset:16384
 ds_read_b64_tr_b16 v[194:195], v4 offset:17408
 v_mfma_f32_32x32x16_bf16 v[104:119], v[36:39], v[124:127], 0
 ds_read_b64_tr_b16 v[196:197], v12 offset:16384
 ds_read_b64_tr_b16 v[198:199], v12 offset:17408
 s_waitcnt lgkmcnt(11)
 ds_read_b64_tr_b16 v[200:201], v13 offset:16384
 ds_read_b64_tr_b16 v[202:203], v13 offset:17408
 ds_read_b64_tr_b16 v[204:205], v15 offset:16384
 ds_read_b64_tr_b16 v[206:207], v15 offset:17408
 s_waitcnt lgkmcnt(11)
 ds_read_b64_tr_b16 v[208:209], v4 offset:20480
 ds_read_b64_tr_b16 v[210:211], v4 offset:21504
 v_max3_f32 v120, v88, v89, v90
 v_max3_f32 v121, v91, v92, v93
 v_max3_f32 v120, v94, v95, v120
 v_max3_f32 v121, v96, v97, v121
 v_max3_f32 v120, v98, v99, v120
 v_max3_f32 v121, v100, v101, v121
 v_max3_f32 v120, v102, v103, v120
 v_max_f32 v120, v120, v121
 v_mul_f32 v120, v120, v16
 v_pk_fma_f32 v[88:89], v[88:89], v[16:17], v[120:121] op_sel_hi:[1,0,0] neg_lo:[0,0,1] neg_hi:[0,0,1]
 v_pk_fma_f32 v[90:91], v[90:91], v[16:17], v[120:121] op_sel_hi:[1,0,0] neg_lo:[0,0,1] neg_hi:[0,0,1]
 v_pk_fma_f32 v[92:93], v[92:93], v[16:17], v[120:121] op_sel_hi:[1,0,0] neg_lo:[0,0,1] neg_hi:[0,0,1]
 v_pk_fma_f32 v[94:95], v[94:95], v[16:17], v[120:121] op_sel_hi:[1,0,0] neg_lo:[0,0,1] neg_hi:[0,0,1]
 v_pk_fma_f32 v[96:97], v[96:97], v[16:17], v[120:121] op_sel_hi:[1,0,0] neg_lo:[0,0,1] neg_hi:[0,0,1]
 v_pk_fma_f32 v[98:99], v[98:99], v[16:17], v[120:121] op_sel_hi:[1,0,0] neg_lo:[0,0,1] neg_hi:[0,0,1]
 v_pk_fma_f32 v[100:101], v[100:101], v[16:17], v[120:121] op_sel_hi:[1,0,0] neg_lo:[0,0,1] neg_hi:[0,0,1]
 v_pk_fma_f32 v[102:103], v[102:103], v[16:17], v[120:121] op_sel_hi:[1,0,0] neg_lo:[0,0,1] neg_hi:[0,0,1]
 v_exp_f32 v88, v88
 v_exp_f32 v89, v89
 v_exp_f32 v90, v90
 v_exp_f32 v91, v91
 v_exp_f32 v92, v92
 v_exp_f32 v93, v93
 v_exp_f32 v94, v94
 v_exp_f32 v95, v95
 v_exp_f32 v96, v96
 v_exp_f32 v97, v97
 v_exp_f32 v98, v98
 v_exp_f32 v99, v99
 v_exp_f32 v100, v100
 v_exp_f32 v101, v101
 v_exp_f32 v102, v102
 v_exp_f32 v103, v103
 v_pk_add_f32 v[124:125], v[88:89], v[90:91]
 v_pk_add_f32 v[124:125], v[124:125], v[92:93]
 v_pk_add_f32 v[124:125], v[124:125], v[94:95]
 v_pk_add_f32 v[124:125], v[124:125], v[96:97]
 v_pk_add_f32 v[124:125], v[124:125], v[98:99]
 v_pk_add_f32 v[124:125], v[124:125], v[100:101]
 v_pk_add_f32 v[124:125], v[124:125], v[102:103]
 v_add_f32 v124, v124, v125
 v_rcp_f32_e64 v124, v124
 s_nop 0
 v_pk_mul_f32 v[88:89], v[88:89], v[124:125] op_sel_hi:[1,0]
 v_pk_mul_f32 v[90:91], v[90:91], v[124:125] op_sel_hi:[1,0]
 v_pk_mul_f32 v[92:93], v[92:93], v[124:125] op_sel_hi:[1,0]
 v_pk_mul_f32 v[94:95], v[94:95], v[124:125] op_sel_hi:[1,0]
 v_pk_mul_f32 v[96:97], v[96:97], v[124:125] op_sel_hi:[1,0]
 v_pk_mul_f32 v[98:99], v[98:99], v[124:125] op_sel_hi:[1,0]
 v_pk_mul_f32 v[100:101], v[100:101], v[124:125] op_sel_hi:[1,0]
 v_pk_mul_f32 v[102:103], v[102:103], v[124:125] op_sel_hi:[1,0]
 v_cvt_pk_bf16_f32 v56, v88, v89
 v_cvt_pk_bf16_f32 v57, v90, v91
 v_cvt_pk_bf16_f32 v58, v92, v93
 v_cvt_pk_bf16_f32 v59, v94, v95
 v_cvt_pk_bf16_f32 v60, v96, v97
 v_cvt_pk_bf16_f32 v61, v98, v99
 v_cvt_pk_bf16_f32 v62, v100, v101
 v_cvt_pk_bf16_f32 v63, v102, v103
 v_max3_f32 v122, v104, v105, v106
 v_max3_f32 v123, v107, v108, v109
 v_max3_f32 v122, v110, v111, v122
 v_max3_f32 v123, v112, v113, v123
 v_max3_f32 v122, v114, v115, v122
 v_max3_f32 v123, v116, v117, v123
 v_max3_f32 v122, v118, v119, v122
 v_max_f32 v122, v122, v123
 v_mul_f32 v122, v122, v16
 v_pk_fma_f32 v[104:105], v[104:105], v[16:17], v[122:123] op_sel_hi:[1,0,0] neg_lo:[0,0,1] neg_hi:[0,0,1]
 v_pk_fma_f32 v[106:107], v[106:107], v[16:17], v[122:123] op_sel_hi:[1,0,0] neg_lo:[0,0,1] neg_hi:[0,0,1]
 v_pk_fma_f32 v[108:109], v[108:109], v[16:17], v[122:123] op_sel_hi:[1,0,0] neg_lo:[0,0,1] neg_hi:[0,0,1]
 v_pk_fma_f32 v[110:111], v[110:111], v[16:17], v[122:123] op_sel_hi:[1,0,0] neg_lo:[0,0,1] neg_hi:[0,0,1]
 v_pk_fma_f32 v[112:113], v[112:113], v[16:17], v[122:123] op_sel_hi:[1,0,0] neg_lo:[0,0,1] neg_hi:[0,0,1]
 v_pk_fma_f32 v[114:115], v[114:115], v[16:17], v[122:123] op_sel_hi:[1,0,0] neg_lo:[0,0,1] neg_hi:[0,0,1]
 v_pk_fma_f32 v[116:117], v[116:117], v[16:17], v[122:123] op_sel_hi:[1,0,0] neg_lo:[0,0,1] neg_hi:[0,0,1]
 v_pk_fma_f32 v[118:119], v[118:119], v[16:17], v[122:123] op_sel_hi:[1,0,0] neg_lo:[0,0,1] neg_hi:[0,0,1]
 v_exp_f32 v104, v104
 v_exp_f32 v105, v105
 v_exp_f32 v106, v106
 v_exp_f32 v107, v107
 v_exp_f32 v108, v108
 v_exp_f32 v109, v109
 v_exp_f32 v110, v110
 v_exp_f32 v111, v111
 v_exp_f32 v112, v112
 v_exp_f32 v113, v113
 v_exp_f32 v114, v114
 v_exp_f32 v115, v115
 v_exp_f32 v116, v116
 v_exp_f32 v117, v117
 v_exp_f32 v118, v118
 v_exp_f32 v119, v119
 v_pk_add_f32 v[126:127], v[104:105], v[106:107]
 v_pk_add_f32 v[126:127], v[126:127], v[108:109]
 v_pk_add_f32 v[126:127], v[126:127], v[110:111]
 v_pk_add_f32 v[126:127], v[126:127], v[112:113]
 v_pk_add_f32 v[126:127], v[126:127], v[114:115]
 v_pk_add_f32 v[126:127], v[126:127], v[116:117]
 v_pk_add_f32 v[126:127], v[126:127], v[118:119]
 v_add_f32 v126, v126, v127
 v_rcp_f32_e64 v126, v126
 s_nop 0
 v_pk_mul_f32 v[104:105], v[104:105], v[126:127] op_sel_hi:[1,0]
 v_pk_mul_f32 v[106:107], v[106:107], v[126:127] op_sel_hi:[1,0]
 v_pk_mul_f32 v[108:109], v[108:109], v[126:127] op_sel_hi:[1,0]
 v_pk_mul_f32 v[110:111], v[110:111], v[126:127] op_sel_hi:[1,0]
 v_pk_mul_f32 v[112:113], v[112:113], v[126:127] op_sel_hi:[1,0]
 v_pk_mul_f32 v[114:115], v[114:115], v[126:127] op_sel_hi:[1,0]
 v_pk_mul_f32 v[116:117], v[116:117], v[126:127] op_sel_hi:[1,0]
 v_pk_mul_f32 v[118:119], v[118:119], v[126:127] op_sel_hi:[1,0]
 v_cvt_pk_bf16_f32 v64, v104, v105
 v_cvt_pk_bf16_f32 v65, v106, v107
 v_cvt_pk_bf16_f32 v66, v108, v109
 v_cvt_pk_bf16_f32 v67, v110, v111
 v_cvt_pk_bf16_f32 v68, v112, v113
 v_cvt_pk_bf16_f32 v69, v114, v115
 v_cvt_pk_bf16_f32 v70, v116, v117
 v_cvt_pk_bf16_f32 v71, v118, v119
 ds_read_b64_tr_b16 v[212:213], v12 offset:20480
 ds_read_b64_tr_b16 v[214:215], v12 offset:21504
 s_waitcnt lgkmcnt(11)
 ds_read_b64_tr_b16 v[216:217], v13 offset:20480
 ds_read_b64_tr_b16 v[218:219], v13 offset:21504
 ds_read_b64_tr_b16 v[220:221], v15 offset:20480
 ds_read_b64_tr_b16 v[222:223], v15 offset:21504
 s_barrier
 s_waitcnt lgkmcnt(11)
 ds_read_b128 v[240:243], v14 offset:0
 ds_read_b128 v[244:247], v14 offset:512
 ds_read_b128 v[248:251], v14 offset:8704
 ds_read_b128 v[252:255], v14 offset:9216
 s_waitcnt lgkmcnt(3)
 v_mfma_f32_32x32x16_bf16 v[88:103], v[240:243], v[56:59], 0
 s_waitcnt lgkmcnt(2)
 v_mfma_f32_32x32x16_bf16 v[88:103], v[244:247], v[60:63], v[88:103]
 s_waitcnt lgkmcnt(1)
 v_mfma_f32_32x32x16_bf16 v[104:119], v[248:251], v[64:67], 0
 s_nop 5
 s_waitcnt lgkmcnt(0)
 v_mfma_f32_32x32x16_bf16 v[104:119], v[252:255], v[68:71], v[104:119]
 s_cmp_lg_u32 s63, 0
 s_cbranch_scc1 Lsl18
 v_add_f32 v96, 0x358637bd, v96
 v_rcp_f32 v96, v96
 s_nop 0
 v_mul_f32 v88, v88, v96
 v_mul_f32 v89, v89, v96
 v_mul_f32 v90, v90, v96
 v_mul_f32 v91, v91, v96
 v_mul_f32 v92, v92, v96
 v_mul_f32 v93, v93, v96
 v_mul_f32 v94, v94, v96
 v_mul_f32 v95, v95, v96
 v_cvt_pk_bf16_f32 v120, v88, v89
 v_cvt_pk_bf16_f32 v121, v90, v91
 v_cvt_pk_bf16_f32 v122, v92, v93
 v_cvt_pk_bf16_f32 v123, v94, v95
 v_and_or_b32 v123, v123, -2, s65
 buffer_store_dwordx4 v[120:123], v1, s[28:31], s10 offen
 v_add_f32 v112, 0x358637bd, v112
 v_rcp_f32 v112, v112
 s_nop 0
 v_pk_mul_f32 v[104:105], v[104:105], v[112:113] op_sel_hi:[1,0]
 v_pk_mul_f32 v[106:107], v[106:107], v[112:113] op_sel_hi:[1,0]
 v_pk_mul_f32 v[108:109], v[108:109], v[112:113] op_sel_hi:[1,0]
 v_pk_mul_f32 v[110:111], v[110:111], v[112:113] op_sel_hi:[1,0]
 v_cvt_pk_bf16_f32 v124, v104, v105
 v_cvt_pk_bf16_f32 v125, v106, v107
 v_cvt_pk_bf16_f32 v126, v108, v109
 v_cvt_pk_bf16_f32 v127, v110, v111
 v_and_or_b32 v127, v127, -2, s65
 s_mov_b64 exec, 1
 buffer_store_dword v6, v0, s[28:31], s13 offen
 s_mov_b64 exec, -1
 buffer_store_dwordx4 v[124:127], v1, s[28:31], s15 offen
Lbk19:
 v_lshrrev_b32_e64 v56, 1, v2
 v_and_b32 v56, 0xf8, v56
 v_add_u32_e64 v56, s17, v56
 ds_read_b64_tr_b16 v[32:33], v56 offset:0
 ds_read_b64_tr_b16 v[34:35], v56 offset:256
 ds_read_b64_tr_b16 v[36:37], v56 offset:512
 ds_read_b64_tr_b16 v[38:39], v56 offset:768
 v_bfe_u32 v57, v1, 6, 1
 v_mul_u32_u24 v57, 0x8000, v57
 v_lshl_add_u32 v57, v57, 16, v57
 ds_read_b64_tr_b16 v[72:73], v4 offset:24576
 ds_read_b64_tr_b16 v[74:75], v4 offset:25600
 ds_read_b64_tr_b16 v[76:77], v12 offset:24576
 ds_read_b64_tr_b16 v[78:79], v12 offset:25600
 ds_read_b64_tr_b16 v[80:81], v13 offset:24576
 ds_read_b64_tr_b16 v[82:83], v13 offset:25600
 ds_read_b64_tr_b16 v[84:85], v15 offset:24576
 ds_read_b64_tr_b16 v[86:87], v15 offset:25600
 ds_read_b64_tr_b16 v[88:89], v4 offset:28672
 ds_read_b64_tr_b16 v[90:91], v4 offset:29696
 ds_read_b64_tr_b16 v[92:93], v12 offset:28672
 s_waitcnt lgkmcnt(11)
 ds_read_b64_tr_b16 v[94:95], v12 offset:29696
 ds_read_b64_tr_b16 v[96:97], v13 offset:28672
 ds_read_b64_tr_b16 v[98:99], v13 offset:29696
 ds_read_b64_tr_b16 v[100:101], v15 offset:28672
 s_waitcnt lgkmcnt(11)
 ds_read_b64_tr_b16 v[102:103], v15 offset:29696
 ds_read_b64_tr_b16 v[104:105], v4 offset:32768
 ds_read_b64_tr_b16 v[106:107], v4 offset:33792
 ds_read_b64_tr_b16 v[108:109], v12 offset:32768
 s_waitcnt lgkmcnt(11)
 ds_read_b64_tr_b16 v[110:111], v12 offset:33792
 ds_read_b64_tr_b16 v[112:113], v13 offset:32768
 ds_read_b64_tr_b16 v[114:115], v13 offset:33792
 ds_read_b64_tr_b16 v[116:117], v15 offset:32768
 v_xor_b32 v32, v57, v32
 v_xor_b32 v33, v57, v33
 v_xor_b32 v34, v57, v34
 v_xor_b32 v35, v57, v35
 v_xor_b32 v36, v57, v36
 v_xor_b32 v37, v57, v37
 v_xor_b32 v38, v57, v38
 v_xor_b32 v39, v57, v39
 s_waitcnt lgkmcnt(14)
Loc20:
 buffer_load_dword v18, v0, s[28:31], s14 offen sc1
 buffer_load_dwordx4 v[224:227], v31, s[28:31], s77 offen offset:0 sc1
 ds_read_b64_tr_b16 v[118:119], v15 offset:33792
 buffer_load_dwordx4 v[228:231], v31, s[28:31], s77 offen offset:2048 sc1
 s_sub_u32 s64, s64, 1
 s_cbranch_scc1 Lexit2
 s_waitcnt vmcnt(2) lgkmcnt(0)
 v_cmp_ne_u32_e64 vcc, s65, v18
 s_cbranch_vccnz Loc20
 buffer_load_dwordx4 v[232:235], v31, s[28:31], s78 offen offset:0 sc1
 buffer_load_dwordx4 v[236:239], v31, s[28:31], s78 offen offset:2048 sc1
 s_waitcnt vmcnt(3) lgkmcnt(0)
 v_mfma_f32_16x16x32_bf16 v[56:59], v[128:131], v[224:227], v[40:43]
 buffer_load_dwordx4 v[240:243], v31, s[28:31], s79 offen offset:0 sc1
 ds_read_b64_tr_b16 v[128:129], v4 offset:36864
 v_mfma_f32_16x16x32_bf16 v[60:63], v[132:135], v[224:227], v[44:47]
 ds_read_b64_tr_b16 v[130:131], v4 offset:37888
 v_xor_b32 v18, s65, v227
 v_mfma_f32_16x16x32_bf16 v[64:67], v[136:139], v[224:227], v[48:51]
 ds_read_b64_tr_b16 v[132:133], v12 offset:36864
 v_mfma_f32_16x16x32_bf16 v[68:71], v[140:143], v[224:227], v[52:55]
 ds_read_b64_tr_b16 v[134:135], v12 offset:37888
 s_waitcnt vmcnt(3) lgkmcnt(4)
 v_mfma_f32_16x16x32_bf16 v[56:59], v[144:147], v[228:231], v[56:59]
 buffer_load_dwordx4 v[244:247], v31, s[28:31], s79 offen offset:2048 sc1
 ds_read_b64_tr_b16 v[136:137], v13 offset:36864
 v_mfma_f32_16x16x32_bf16 v[60:63], v[148:151], v[228:231], v[60:63]
Lhop6:
 s_cbranch_execz Lhop10
 ds_read_b64_tr_b16 v[138:139], v13 offset:37888
 v_bitop3_b32 v18, v231, v18, s65 bitop3:0xde
 v_mfma_f32_16x16x32_bf16 v[64:67], v[152:155], v[228:231], v[64:67]
 ds_read_b64_tr_b16 v[140:141], v15 offset:36864
 v_mfma_f32_16x16x32_bf16 v[68:71], v[156:159], v[228:231], v[68:71]
 ds_read_b64_tr_b16 v[142:143], v15 offset:37888
 v_and_b32 v20, 1, v18
 v_cmp_ne_u32 vcc, 0, v20
 s_cbranch_vccnz Lrt21
 s_waitcnt vmcnt(3) lgkmcnt(8)
 v_mfma_f32_16x16x32_bf16 v[56:59], v[160:163], v[232:235], v[56:59]
 buffer_load_dwordx4 v[248:251], v31, s[28:31], s80 offen offset:0 sc1
 ds_read_b64_tr_b16 v[144:145], v4 offset:40960
 v_mfma_f32_16x16x32_bf16 v[60:63], v[164:167], v[232:235], v[60:63]
 ds_read_b64_tr_b16 v[146:147], v4 offset:41984
 v_bitop3_b32 v18, v235, v18, s65 bitop3:0xde
 v_mfma_f32_16x16x32_bf16 v[64:67], v[168:171], v[232:235], v[64:67]
 ds_read_b64_tr_b16 v[148:149], v12 offset:40960
 v_mfma_f32_16x16x32_bf16 v[68:71], v[172:175], v[232:235], v[68:71]
 ds_read_b64_tr_b16 v[150:151], v12 offset:41984
 s_waitcnt vmcnt(3) lgkmcnt(11)
 v_mfma_f32_16x16x32_bf16 v[56:59], v[176:179], v[236:239], v[56:59]
 buffer_load_dwordx4 v[252:255], v31, s[28:31], s80 offen offset:2048 sc1
 ds_read_b64_tr_b16 v[152:153], v13 offset:40960
 v_mfma_f32_16x16x32_bf16 v[60:63], v[180:183], v[236:239], v[60:63]
 ds_read_b64_tr_b16 v[154:155], v13 offset:41984
 v_bitop3_b32 v18, v239, v18, s65 bitop3:0xde
 v_mfma_f32_16x16x32_bf16 v[64:67], v[184:187], v[236:239], v[64:67]
 ds_read_b64_tr_b16 v[156:157], v15 offset:40960
 v_mfma_f32_16x16x32_bf16 v[68:71], v[188:191], v[236:239], v[68:71]
 ds_read_b64_tr_b16 v[158:159], v15 offset:41984
 s_waitcnt vmcnt(3) lgkmcnt(11)
 v_mfma_f32_16x16x32_bf16 v[56:59], v[192:195], v[240:243], v[56:59]
 buffer_load_dwordx4 v[224:227], v31, s[28:31], s81 offen offset:0 sc1
 ds_read_b64_tr_b16 v[160:161], v4 offset:45056
 v_mfma_f32_16x16x32_bf16 v[60:63], v[196:199], v[240:243], v[60:63]
 ds_read_b64_tr_b16 v[162:163], v4 offset:46080
 v_bitop3_b32 v18, v243, v18, s65 bitop3:0xde
 v_mfma_f32_16x16x32_bf16 v[64:67], v[200:203], v[240:243], v[64:67]
 ds_read_b64_tr_b16 v[164:165], v12 offset:45056
 v_mfma_f32_16x16x32_bf16 v[68:71], v[204:207], v[240:243], v[68:71]
 ds_read_b64_tr_b16 v[166:167], v12 offset:46080
 s_waitcnt vmcnt(3) lgkmcnt(11)
 v_mfma_f32_16x16x32_bf16 v[56:59], v[208:211], v[244:247], v[56:59]
 buffer_load_dwordx4 v[228:231], v31, s[28:31], s81 offen offset:2048 sc1
 ds_read_b64_tr_b16 v[168:169], v13 offset:45056
 v_mfma_f32_16x16x32_bf16 v[60:63], v[212:215], v[244:247], v[60:63]
 ds_read_b64_tr_b16 v[170:171], v13 offset:46080
 v_bitop3_b32 v18, v247, v18, s65 bitop3:0xde
 v_mfma_f32_16x16x32_bf16 v[64:67], v[216:219], v[244:247], v[64:67]
 ds_read_b64_tr_b16 v[172:173], v15 offset:45056
 v_mfma_f32_16x16x32_bf16 v[68:71], v[220:223], v[244:247], v[68:71]
 ds_read_b64_tr_b16 v[174:175], v15 offset:46080
 s_waitcnt vmcnt(3) lgkmcnt(11)
 v_mfma_f32_16x16x32_bf16 v[56:59], v[72:75], v[248:251], v[56:59]
 buffer_load_dwordx4 v[232:235], v31, s[28:31], s82 offen offset:0 sc1
 ds_read_b64_tr_b16 v[176:177], v4 offset:49152
 v_mfma_f32_16x16x32_bf16 v[60:63], v[76:79], v[248:251], v[60:63]
 ds_read_b64_tr_b16 v[178:179], v4 offset:50176
 v_bitop3_b32 v18, v251, v18, s65 bitop3:0xde
 v_mfma_f32_16x16x32_bf16 v[64:67], v[80:83], v[248:251], v[64:67]
 ds_read_b64_tr_b16 v[180:181], v12 offset:49152
 v_mfma_f32_16x16x32_bf16 v[68:71], v[84:87], v[248:251], v[68:71]
 ds_read_b64_tr_b16 v[182:183], v12 offset:50176
 s_waitcnt vmcnt(3) lgkmcnt(11)
 v_mfma_f32_16x16x32_bf16 v[56:59], v[88:91], v[252:255], v[56:59]
 buffer_load_dwordx4 v[236:239], v31, s[28:31], s82 offen offset:2048 sc1
 ds_read_b64_tr_b16 v[184:185], v13 offset:49152
 v_mfma_f32_16x16x32_bf16 v[60:63], v[92:95], v[252:255], v[60:63]
 ds_read_b64_tr_b16 v[186:187], v13 offset:50176
 v_bitop3_b32 v18, v255, v18, s65 bitop3:0xde
 v_mfma_f32_16x16x32_bf16 v[64:67], v[96:99], v[252:255], v[64:67]
 ds_read_b64_tr_b16 v[188:189], v15 offset:49152
 v_mfma_f32_16x16x32_bf16 v[68:71], v[100:103], v[252:255], v[68:71]
 ds_read_b64_tr_b16 v[190:191], v15 offset:50176
 s_waitcnt vmcnt(3) lgkmcnt(11)
 v_mfma_f32_16x16x32_bf16 v[56:59], v[104:107], v[224:227], v[56:59]
 buffer_load_dwordx4 v[240:243], v31, s[28:31], s83 offen offset:0 sc1
 ds_read_b64_tr_b16 v[192:193], v4 offset:53248
 v_mfma_f32_16x16x32_bf16 v[60:63], v[108:111], v[224:227], v[60:63]
 ds_read_b64_tr_b16 v[194:195], v4 offset:54272
 v_bitop3_b32 v18, v227, v18, s65 bitop3:0xde
 v_mfma_f32_16x16x32_bf16 v[64:67], v[112:115], v[224:227], v[64:67]
 ds_read_b64_tr_b16 v[196:197], v12 offset:53248
 v_mfma_f32_16x16x32_bf16 v[68:71], v[116:119], v[224:227], v[68:71]
 ds_read_b64_tr_b16 v[198:199], v12 offset:54272
 s_waitcnt vmcnt(3) lgkmcnt(11)
 v_mfma_f32_16x16x32_bf16 v[56:59], v[128:131], v[228:231], v[56:59]
 buffer_load_dwordx4 v[244:247], v31, s[28:31], s83 offen offset:2048 sc1
 ds_read_b64_tr_b16 v[200:201], v13 offset:53248
 v_mfma_f32_16x16x32_bf16 v[60:63], v[132:135], v[228:231], v[60:63]
 ds_read_b64_tr_b16 v[202:203], v13 offset:54272
 v_bitop3_b32 v18, v231, v18, s65 bitop3:0xde
 v_mfma_f32_16x16x32_bf16 v[64:67], v[136:139], v[228:231], v[64:67]
 ds_read_b64_tr_b16 v[204:205], v15 offset:53248
 v_mfma_f32_16x16x32_bf16 v[68:71], v[140:143], v[228:231], v[68:71]
 ds_read_b64_tr_b16 v[206:207], v15 offset:54272
 s_waitcnt vmcnt(3) lgkmcnt(11)
 v_mfma_f32_16x16x32_bf16 v[56:59], v[144:147], v[232:235], v[56:59]
 buffer_load_dwordx4 v[248:251], v31, s[28:31], s84 offen offset:0 sc1
 ds_read_b64_tr_b16 v[208:209], v4 offset:57344
 v_mfma_f32_16x16x32_bf16 v[60:63], v[148:151], v[232:235], v[60:63]
 ds_read_b64_tr_b16 v[210:211], v4 offset:58368
 v_bitop3_b32 v18, v235, v18, s65 bitop3:0xde
 v_mfma_f32_16x16x32_bf16 v[64:67], v[152:155], v[232:235], v[64:67]
 ds_read_b64_tr_b16 v[212:213], v12 offset:57344
 v_mfma_f32_16x16x32_bf16 v[68:71], v[156:159], v[232:235], v[68:71]
 ds_read_b64_tr_b16 v[214:215], v12 offset:58368
 s_waitcnt vmcnt(3) lgkmcnt(11)
 v_mfma_f32_16x16x32_bf16 v[56:59], v[160:163], v[236:239], v[56:59]
 buffer_load_dwordx4 v[252:255], v31, s[28:31], s84 offen offset:2048 sc1
 ds_read_b64_tr_b16 v[216:217], v13 offset:57344
 v_mfma_f32_16x16x32_bf16 v[60:63], v[164:167], v[236:239], v[60:63]
 ds_read_b64_tr_b16 v[218:219], v13 offset:58368
 v_bitop3_b32 v18, v239, v18, s65 bitop3:0xde
 v_mfma_f32_16x16x32_bf16 v[64:67], v[168:171], v[236:239], v[64:67]
 ds_read_b64_tr_b16 v[220:221], v15 offset:57344
 v_mfma_f32_16x16x32_bf16 v[68:71], v[172:175], v[236:239], v[68:71]
 ds_read_b64_tr_b16 v[222:223], v15 offset:58368
 s_waitcnt vmcnt(3) lgkmcnt(11)
 v_mfma_f32_16x16x32_bf16 v[56:59], v[176:179], v[240:243], v[56:59]
 ds_read_b64_tr_b16 v[72:73], v4 offset:61440
 v_mfma_f32_16x16x32_bf16 v[60:63], v[180:183], v[240:243], v[60:63]
 ds_read_b64_tr_b16 v[74:75], v4 offset:62464
 v_bitop3_b32 v18, v243, v18, s65 bitop3:0xde
 v_mfma_f32_16x16x32_bf16 v[64:67], v[184:187], v[240:243], v[64:67]
 ds_read_b64_tr_b16 v[76:77], v12 offset:61440
 v_mfma_f32_16x16x32_bf16 v[68:71], v[188:191], v[240:243], v[68:71]
 ds_read_b64_tr_b16 v[78:79], v12 offset:62464
 s_waitcnt vmcnt(2) lgkmcnt(11)
 v_mfma_f32_16x16x32_bf16 v[56:59], v[192:195], v[244:247], v[56:59]
 ds_read_b64_tr_b16 v[80:81], v13 offset:61440
 v_mfma_f32_16x16x32_bf16 v[60:63], v[196:199], v[244:247], v[60:63]
 ds_read_b64_tr_b16 v[82:83], v13 offset:62464
 v_bitop3_b32 v18, v247, v18, s65 bitop3:0xde
 v_mfma_f32_16x16x32_bf16 v[64:67], v[200:203], v[244:247], v[64:67]
 ds_read_b64_tr_b16 v[84:85], v15 offset:61440
 v_mfma_f32_16x16x32_bf16 v[68:71], v[204:207], v[244:247], v[68:71]
 ds_read_b64_tr_b16 v[86:87], v15 offset:62464
 s_waitcnt vmcnt(1) lgkmcnt(8)
 v_mfma_f32_16x16x32_bf16 v[56:59], v[208:211], v[248:251], v[56:59]
 v_mov_b32_e64 v88, s94
 v_mfma_f32_16x16x32_bf16 v[60:63], v[212:215], v[248:251], v[60:63]
 v_bitop3_b32 v18, v251, v18, s65 bitop3:0xde
 v_mov_b32_e64 v89, s94
 v_mfma_f32_16x16x32_bf16 v[64:67], v[216:219], v[248:251], v[64:67]
 v_mov_b32_e64 v90, s94
 v_mfma_f32_16x16x32_bf16 v[68:71], v[220:223], v[248:251], v[68:71]
 v_mov_b32 v91, s94
 s_waitcnt vmcnt(0) lgkmcnt(0)
 v_mfma_f32_16x16x32_bf16 v[56:59], v[72:75], v[252:255], v[56:59]
 v_bitop3_b32 v18, v255, v18, s65 bitop3:0xde
 v_and_b32_e64 v20, 1, v18
 v_mfma_f32_16x16x32_bf16 v[60:63], v[76:79], v[252:255], v[60:63]
 v_cmp_ne_u32_e64 vcc, 0, v20
 s_lshr_b32 s88, s85, 4
 s_cmp_eq_u32 s88, 3
 v_mfma_f32_16x16x32_bf16 v[64:67], v[80:83], v[252:255], v[64:67]
 s_cbranch_vccnz Lrt22
 s_cselect_b32 s88, 1, s63
 v_mfma_f32_16x16x32_bf16 v[68:71], v[84:87], v[252:255], v[68:71]
 s_xor_b32 s65, s65, 1
 s_cmp_lg_u32 s88, 0
 s_cbranch_scc1 Lrare
 v_cvt_pk_bf16_f32 v123, v62, v63
 v_cvt_pk_bf16_f32 v120, v56, v57
 v_and_or_b32 v123, v123, -2, s65
 v_cvt_pk_bf16_f32 v121, v58, v59
 v_cvt_pk_bf16_f32 v122, v60, v61
 s_nop 1
 v_mfma_f32_16x16x32_bf16 v[96:99], v[120:123], v[120:123], 0
 v_mfma_f32_16x16x32_bf16 v[92:95], v[88:91], v[120:123], 0
 buffer_store_dwordx4 v[120:123], v31, s[36:39], s11 offen offset:0
 v_cvt_pk_bf16_f32 v127, v70, v71
 v_cvt_pk_bf16_f32 v124, v64, v65
 v_and_or_b32 v127, v127, -2, s65
 v_cvt_pk_bf16_f32 v125, v66, v67
 v_cvt_pk_bf16_f32 v126, v68, v69
 s_nop 1
 v_mfma_f32_16x16x32_bf16 v[96:99], v[124:127], v[124:127], v[96:99]
 v_mfma_f32_16x16x32_bf16 v[92:95], v[88:91], v[124:127], v[92:95]
 buffer_store_dwordx4 v[124:127], v31, s[36:39], s11 offen offset:2048
 s_nop 5
 v_cndmask_b32 v96, v96, v97, s[44:45]
 v_cndmask_b32 v98, v98, v99, s[44:45]
 v_cndmask_b32 v96, v96, v98, s[46:47]
 v_mul_f32 v92, 0.125, v92
 v_fma_f32 v96, -v92, v92, v96
 v_cvt_pk_bf16_f32 v92, v92, v96
 v_and_or_b32 v92, v92, -2, s65
 buffer_store_dword v92, v29, s[28:31], s12 offen
Lnext:
 s_add_u32 s85, s85, 16
 s_branch Ltop
Lrare:
 s_cmp_lg_u32 s85, 48
 s_cbranch_scc1 Lslow
 v_xor_b32 v73, 32, v21
 v_xor_b32 v74, 64, v21
 v_xor_b32 v75, 96, v21
 s_lshl_b32 s89, s60, 11
 s_add_u32 s89, s89, 148480
 v_add_u32 v76, s89, v1
 s_add_u32 s88, s95, 8192
 v_cvt_pk_bf16_f32 v120, v56, v57
 v_cvt_pk_bf16_f32 v121, v58, v59
 ds_write_b64 v21, v[120:121] offset:17408
 v_cvt_pk_bf16_f32 v122, v60, v61
 v_cvt_pk_bf16_f32 v123, v62, v63
 ds_write_b64 v73, v[122:123] offset:17408
 v_cvt_pk_bf16_f32 v124, v64, v65
 v_cvt_pk_bf16_f32 v125, v66, v67
 ds_write_b64 v74, v[124:125] offset:17408
 v_cvt_pk_bf16_f32 v126, v68, v69
 v_cvt_pk_bf16_f32 v127, v70, v71
 ds_write_b64 v75, v[126:127] offset:17408
 s_waitcnt lgkmcnt(0)
 ds_read_b128 v[88:91], v76
 ds_read_b128 v[92:95], v76 offset:1024
 s_waitcnt lgkmcnt(1)
 buffer_store_dwordx4 v[88:91], v5, s[36:39], s95 offen
 s_waitcnt lgkmcnt(0)
 buffer_store_dwordx4 v[92:95], v5, s[36:39], s88 offen
Lexit2:
 s_endpgm
Lhelper:
 v_and_b32 v45, 3, v40
 v_lshrrev_b32 v42, 5, v40
 v_bfe_u32 v43, v40, 4, 1
 v_bfe_u32 v44, v40, 2, 2
 v_lshrrev_b32_e64 v46, 2, v40
 v_lshl_add_u32 v50, v42, 2, v44
 v_lshlrev_b32_e64 v50, 6, v50
 v_lshl_add_u32 v50, v43, 5, v50
 v_lshl_add_u32 v2, v45, 3, v50
 v_bfe_u32 v50, v40, 1, 2
 v_xor_b32 v50, v50, v48
 v_lshrrev_b32 v51, 3, v40
 v_lshlrev_b32_e64 v5, 10, v51
 v_lshl_add_u32 v5, v50, 5, v5
 v_and_b32_e64 v50, 1, v40
 v_lshl_add_u32 v5, v50, 4, v5
 s_mov_b32 s24, s16
 s_mov_b32 s25, s17
 s_mov_b32 s26, 16384
 s_mov_b32 s27, 0x20000
 v_mul_u32_u24 v6, 3072, v46
 v_lshl_add_u32 v6, v45, 4, v6
 v_mul_u32_u24 v255, 12288, v48
 v_add_u32_e64 v255, v255, v6
 s_and_b32 s90, s61, 1
 s_lshl_b32 s90, s90, 1
 s_and_b32 s88, s62, 1
 s_add_u32 s90, s90, s88
 s_lshl_b32 s66, s62, 6
 s_lshl_b32 s89, s60, 11
 s_and_b32 s88, s90, 1
 s_xor_b32 s88, s88, 0
 s_lshl_b32 s88, s88, 13
 s_add_u32 s72, s88, s89
 s_mul_i32 s68, s72, 48
 s_add_u32 s68, s68, s66
 s_and_b32 s88, s90, 1
 s_xor_b32 s88, s88, 1
 s_lshl_b32 s88, s88, 13
 s_add_u32 s73, s88, s89
 s_mul_i32 s69, s73, 48
 s_add_u32 s69, s69, s66
 s_and_b32 s88, s90, 1
 s_xor_b32 s88, s88, 2
 s_lshl_b32 s88, s88, 13
 s_add_u32 s74, s88, s89
 s_mul_i32 s70, s74, 48
 s_add_u32 s70, s70, s66
 s_and_b32 s88, s90, 1
 s_xor_b32 s88, s88, 3
 s_lshl_b32 s88, s88, 13
 s_add_u32 s75, s88, s89
 s_mul_i32 s71, s75, 48
 s_add_u32 s71, s71, s66
 s_lshl_b32 s77, s60, 10
 s_lshr_b32 s88, s62, 1
 s_lshl_b32 s88, s88, 7
 s_lshr_b32 s76, s60, 1
 s_lshl_b32 s76, s76, 15
 s_add_u32 s88, s88, s76
 s_and_b32 s76, s60, 1
 s_lshl_b32 s76, s76, 13
 s_add_u32 s76, s76, s88
 s_getreg_b32 s65, hwreg(HW_REG_XCC_ID, 0, 4)
 s_or_b32 s65, s65, 0x80
 s_add_u32 s14, s15, s62
 s_cmp_eq_u32 s60, 0
 s_cselect_b32 s14, s14, 0x1000
 v_mov_b32_e64 v232, s65
 v_mov_b32 v233, 162304
 s_lshl_b32 s88, s60, 2
 s_add_u32 s88, s88, 162320
 v_mov_b32 v234, s88
 v_lshlrev_b32_e64 v50, 4, v47
 v_lshl_add_u32 v4, v48, 9, v50
 s_mul_i32 s88, s60, 4352
 s_add_u32 s88, s88, 131072
 v_lshrrev_b32 v50, 1, v45
 v_and_b32 v51, 1, v45
 v_lshlrev_b32_e64 v13, 9, v50
 v_lshl_add_u32 v13, v51, 3, v13
 v_lshl_add_u32 v13, v44, 6, v13
 v_lshl_add_u32 v13, v48, 4, v13
 v_add_u32_e64 v13, s88, v13
 v_add_u32 v13, 256, v13
Lhop7:
 s_cbranch_execz Lhop11
 v_bfe_u32 v50, v40, 3, 1
 v_lshlrev_b32 v12, 9, v42
 v_lshl_add_u32 v12, v50, 3, v12
 v_and_b32_e64 v50, 7, v40
 v_lshl_add_u32 v50, v50, 1, v43
 v_lshl_add_u32 v12, v50, 4, v12
 v_add_u32 v12, s88, v12
 v_lshlrev_b32 v15, 7, v46
 v_lshl_add_u32 v15, v45, 3, v15
 v_and_b32 v50, 1, v40
 v_lshlrev_b32 v50, 4, v50
 s_mov_b32 s88, 0x3f80
 v_lshlrev_b32 v50, v50, s88
 v_lshrrev_b32 v51, 1, v47
 v_cmp_eq_u32 vcc, 0, v51
 s_nop 1
 v_cndmask_b32 v56, 0, v50, vcc
 v_cmp_eq_u32 vcc, 1, v51
 s_nop 1
 v_cndmask_b32 v57, 0, v50, vcc
 v_cmp_eq_u32 vcc, 2, v51
 s_nop 1
 v_cndmask_b32 v58, 0, v50, vcc
 v_cmp_eq_u32 vcc, 3, v51
 s_nop 1
 v_cndmask_b32 v59, 0, v50, vcc
 v_cmp_eq_u32 vcc, 4, v51
 s_nop 1
 v_cndmask_b32 v60, 0, v50, vcc
 v_cmp_eq_u32 vcc, 5, v51
 s_nop 1
 v_cndmask_b32 v61, 0, v50, vcc
 v_cmp_eq_u32 vcc, 6, v51
 s_nop 1
 v_cndmask_b32 v62, 0, v50, vcc
 v_cmp_eq_u32 vcc, 7, v51
 s_nop 1
 v_cndmask_b32_e64 v63, 0, v50, vcc
 s_waitcnt lgkmcnt(0)
 s_mov_b64 exec, 0
 s_cmp_eq_u32 s60, 0
 s_cbranch_scc1 Lhop0
 s_cmp_eq_u32 s60, 1
 s_cbranch_scc1 Lhop1
 s_cmp_eq_u32 s60, 2
 s_cbranch_scc1 Lhop2
 s_branch Lhop3
Lhopret:
 s_mov_b64 exec, -1
 s_waitcnt vmcnt(3)
 s_barrier
 s_setprio 0
 s_mov_b64 exec, 1
 buffer_store_byte v232, v228, s[32:35], s14 offen
 s_mov_b64 exec, -1
 s_waitcnt vmcnt(0)
 s_add_u32 m0, s72, 0
 s_add_u32 s88, s68, 1024
 buffer_load_dwordx4 v255, s[44:47], s88 offen lds
 s_add_u32 m0, s72, 1024
 s_add_u32 s88, s68, 13312
 buffer_load_dwordx4 v255, s[44:47], s88 offen lds
 s_add_u32 m0, s73, 0
 s_add_u32 s88, s69, 1024
 buffer_load_dwordx4 v255, s[44:47], s88 offen lds
 s_add_u32 m0, s73, 1024
 s_add_u32 s88, s69, 13312
 buffer_load_dwordx4 v255, s[44:47], s88 offen lds
 s_waitcnt vmcnt(3)
 s_add_u32 m0, s74, 0
 s_add_u32 s88, s70, 1024
 buffer_load_dwordx4 v255, s[44:47], s88 offen lds
 s_waitcnt vmcnt(3)
 s_add_u32 m0, s74, 1024
 s_add_u32 s88, s70, 13312
 buffer_load_dwordx4 v255, s[44:47], s88 offen lds
 s_waitcnt vmcnt(3)
 s_add_u32 m0, s75, 0
 s_add_u32 s88, s71, 1024
 buffer_load_dwordx4 v255, s[44:47], s88 offen lds
 s_waitcnt vmcnt(3)
 s_add_u32 m0, s75, 1024
 s_add_u32 s88, s71, 13312
 buffer_load_dwordx4 v255, s[44:47], s88 offen lds
 s_waitcnt vmcnt(3)
 buffer_load_dwordx4 v[236:239], v228, s[32:35], s15 offen sc1
 v_mov_b32_e64 v235, 1
 s_mov_b64 exec, 1
 ds_write_b32 v234, v235
 s_mov_b64 exec, -1
 s_add_u32 m0, s72, 32768
 s_add_u32 s88, s68, 2048
 buffer_load_dwordx4 v255, s[44:47], s88 offen lds
 s_waitcnt vmcnt(4)
 s_add_u32 m0, s72, 33792
 s_add_u32 s88, s68, 14336
 buffer_load_dwordx4 v255, s[44:47], s88 offen lds
 s_waitcnt vmcnt(4)
 s_add_u32 m0, s73, 32768
 s_add_u32 s88, s69, 2048
 buffer_load_dwordx4 v255, s[44:47], s88 offen lds
 s_waitcnt vmcnt(4)
 v_mov_b32 v235, 2
 s_mov_b64 exec, 1
 ds_write_b32 v234, v235
 s_mov_b64 exec, -1
 s_add_u32 m0, s73, 33792
 s_add_u32 s88, s69, 14336
 buffer_load_dwordx4 v255, s[44:47], s88 offen lds
 s_waitcnt vmcnt(4)
 s_add_u32 m0, s74, 32768
 s_add_u32 s88, s70, 2048
 buffer_load_dwordx4 v255, s[44:47], s88 offen lds
 s_waitcnt vmcnt(4)
 s_add_u32 m0, s74, 33792
 s_add_u32 s88, s70, 14336
 buffer_load_dwordx4 v255, s[44:47], s88 offen lds
 s_waitcnt vmcnt(4)
 s_add_u32 m0, s75, 32768
 s_add_u32 s88, s71, 2048
 buffer_load_dwordx4 v255, s[44:47], s88 offen lds
 s_waitcnt vmcnt(4)
 s_add_u32 m0, s75, 33792
 s_add_u32 s88, s71, 14336
 buffer_load_dwordx4 v255, s[44:47], s88 offen lds
 s_waitcnt vmcnt(4)
 v_lshlrev_b32_e64 v11, 6, v1
 s_mov_b64 exec, 4095
 buffer_load_dword v14, v11, s[48:51], s79 offen offset:384
 s_mov_b64 exec, -1
 s_waitcnt vmcnt(4)
 s_add_u32 s88, s5, 655360
 s_add_u32 s89, s7, 655360
 buffer_store_dwordx2 v[224:225], v3, s[28:31], s88 offen sc1
 buffer_store_dwordx2 v[224:225], v7, s[28:31], s89 offen sc1
 ds_read_b128 v[244:247], v233 offset:32
 s_waitcnt lgkmcnt(0)
 v_min3_u32 v244, v244, v245, v246
 v_min_u32 v244, v244, v247
 v_cmp_gt_u32_e64 vcc, 2, v244
Law23:
 s_cbranch_vccnz Lax24
 s_waitcnt vmcnt(4)
 s_add_u32 m0, s72, 98304
 s_add_u32 s88, s68, 0
 buffer_load_dwordx4 v255, s[44:47], s88 offen lds
 s_waitcnt vmcnt(4)
 s_add_u32 m0, s72, 99328
 s_add_u32 s88, s68, 12288
 buffer_load_dwordx4 v255, s[44:47], s88 offen lds
 v_mov_b32 v235, 3
 s_mov_b64 exec, 1
 ds_write_b32 v234, v235
 s_mov_b64 exec, -1
 s_mov_b32 s66, 0
Lfchk:
 s_mul_i32 s89, s65, 0x01010101
 v_and_b32 v240, v236, v237
 v_and_b32 v241, v238, v239
 v_and_b32_e64 v240, v240, v241
 v_and_b32 v240, 2155905152, v240
 v_cmp_ne_u32 vcc, 2155905152, v240
 s_cbranch_vccnz Lfretry
 v_xor_b32 v236, s89, v236
 v_xor_b32 v237, s89, v237
 v_xor_b32 v238, s89, v238
 v_xor_b32_e64 v239, s89, v239
 v_or3_b32 v236, v236, v237, v238
 v_or_b32_e64 v236, v236, v239
 v_and_b32 v236, 0x0f0f0f0f, v236
 v_or_b32 v232, 0x40, v232
 v_readfirstlane_b32 s63, v236
 ds_write_b32 v233, v236 offset:12
 s_or_b32 s88, s60, s62
 s_cselect_b32 s89, 0x1000, s15
 s_mov_b64 exec, 1
 buffer_store_byte v232, v228, s[32:35], s89 offen sc1
 s_mov_b64 exec, -1
 v_mov_b32_e64 v235, 4
 s_mov_b64 exec, 1
 ds_write_b32 v234, v235
 s_mov_b64 exec, -1
 s_add_u32 m0, s73, 98304
 s_add_u32 s88, s69, 0
 buffer_load_dwordx4 v255, s[44:47], s88 offen lds
 s_add_u32 m0, s73, 99328
 s_add_u32 s88, s69, 12288
 buffer_load_dwordx4 v255, s[44:47], s88 offen lds
 s_add_u32 m0, s74, 98304
 s_add_u32 s88, s70, 0
 buffer_load_dwordx4 v255, s[44:47], s88 offen lds
 s_add_u32 m0, s74, 99328
 s_add_u32 s88, s70, 12288
 buffer_load_dwordx4 v255, s[44:47], s88 offen lds
 s_add_u32 m0, s75, 98304
 s_add_u32 s88, s71, 0
 buffer_load_dwordx4 v255, s[44:47], s88 offen lds
 s_add_u32 m0, s75, 99328
 s_add_u32 s88, s71, 12288
 buffer_load_dwordx4 v255, s[44:47], s88 offen lds
 s_add_u32 m0, s72, 65536
 s_add_u32 s88, s68, 1024
 buffer_load_dwordx4 v6, s[48:51], s88 offen lds
 s_add_u32 m0, s72, 66560
 s_add_u32 s88, s68, 50176
 buffer_load_dwordx4 v6, s[48:51], s88 offen lds
 s_add_u32 m0, s73, 65536
 s_add_u32 s88, s69, 1024
 buffer_load_dwordx4 v6, s[48:51], s88 offen lds
 s_add_u32 m0, s73, 66560
 s_add_u32 s88, s69, 50176
 buffer_load_dwordx4 v6, s[48:51], s88 offen lds
 s_add_u32 m0, s74, 65536
 s_add_u32 s88, s70, 1024
 buffer_load_dwordx4 v6, s[48:51], s88 offen lds
 s_add_u32 m0, s74, 66560
 s_add_u32 s88, s70, 50176
 buffer_load_dwordx4 v6, s[48:51], s88 offen lds
 s_add_u32 m0, s75, 65536
 s_add_u32 s88, s71, 1024
 buffer_load_dwordx4 v6, s[48:51], s88 offen lds
 s_add_u32 m0, s75, 66560
 s_add_u32 s88, s71, 50176
 buffer_load_dwordx4 v6, s[48:51], s88 offen lds
 s_add_u32 m0, s72, 0
 s_nop 0
 ds_read_addtid_b32 v64 offset:0
 ds_read_addtid_b32 v66 offset:256
 ds_read_addtid_b32 v68 offset:512
 ds_read_addtid_b32 v70 offset:768
 ds_read_addtid_b32 v65 offset:1024
 ds_read_addtid_b32 v67 offset:1280
 ds_read_addtid_b32 v69 offset:1536
 ds_read_addtid_b32 v71 offset:1792
 s_add_u32 m0, s73, 0
 s_nop 0
 ds_read_addtid_b32 v72 offset:0
 ds_read_addtid_b32 v74 offset:256
 ds_read_addtid_b32 v76 offset:512
 ds_read_addtid_b32 v78 offset:768
 s_waitcnt lgkmcnt(11)
 ds_read_addtid_b32 v73 offset:1024
 ds_read_addtid_b32 v75 offset:1280
 ds_read_addtid_b32 v77 offset:1536
 ds_read_addtid_b32 v79 offset:1792
 s_add_u32 m0, s74, 0
 s_nop 0
 s_waitcnt lgkmcnt(11)
 ds_read_addtid_b32 v80 offset:0
 ds_read_addtid_b32 v82 offset:256
 ds_read_addtid_b32 v84 offset:512
 ds_read_addtid_b32 v86 offset:768
 s_waitcnt lgkmcnt(11)
 ds_read_addtid_b32 v81 offset:1024
 ds_read_addtid_b32 v83 offset:1280
 ds_read_addtid_b32 v85 offset:1536
 ds_read_addtid_b32 v87 offset:1792
 s_add_u32 m0, s75, 0
 s_nop 0
 s_waitcnt lgkmcnt(11)
 ds_read_addtid_b32 v88 offset:0
 ds_read_addtid_b32 v90 offset:256
 ds_read_addtid_b32 v92 offset:512
 ds_read_addtid_b32 v94 offset:768
 s_waitcnt lgkmcnt(11)
 ds_read_addtid_b32 v89 offset:1024
 ds_read_addtid_b32 v91 offset:1280
 ds_read_addtid_b32 v93 offset:1536
 ds_read_addtid_b32 v95 offset:1792
 s_lshl_b32 s89, s60, 8
 s_add_u32 m0, s89, 158208
 s_lshl_b32 s88, s62, 10
 s_add_u32 s88, s88, s89
 s_mov_b64 exec, 0xffff
 buffer_load_dwordx4 v1, s[24:27], s88 offen lds
 s_mov_b64 exec, -1
 v_mov_b32 v11, 131072
 s_setprio 2
 s_waitcnt lgkmcnt(0)
 s_mov_b64 exec, 1
 ds_add_u32 v11, v11 offset:31232
 s_mov_b64 exec, -1
 s_branch Lhy26
Lhx25:
 s_sub_u32 s64, s64, 1
 s_cbranch_scc1 Lexit2
 s_sleep 1
Lhy26:
 ds_read_b32 v10, v11 offset:31232
 s_waitcnt lgkmcnt(0)
 v_readfirstlane_b32 s90, v10
 s_cmp_lt_u32 s90, 1048576
 s_cbranch_scc1 Lhx25
 s_cmp_lg_u32 s63, 0
 s_cbranch_scc1 Lsl27
 buffer_store_dwordx4 v[224:227], v1, s[28:31], s10 offen offset:0
 s_add_u32 s88, s10, 16384
 buffer_store_dwordx4 v[224:227], v1, s[28:31], s88 offen offset:0
 buffer_store_dwordx4 v[228:231], v1, s[36:39], s11 offen offset:0
 buffer_store_dwordx4 v[228:231], v1, s[36:39], s11 offen offset:1024
 s_mov_b64 exec, 0xff
 buffer_store_dwordx4 v[228:231], v1, s[28:31], s12 offen
 s_mov_b64 exec, -1
Lbk28:
 s_add_u32 m0, s77, 0
 s_add_u32 s88, s76, 0
 buffer_load_dwordx4 v5, s[52:55], s88 offen lds
 s_add_u32 m0, s77, 4096
 s_add_u32 s88, s76, 65536
 buffer_load_dwordx4 v5, s[52:55], s88 offen lds
 s_add_u32 m0, s77, 8192
 s_add_u32 s88, s76, 131072
 buffer_load_dwordx4 v5, s[52:55], s88 offen lds
 s_add_u32 m0, s77, 12288
 s_add_u32 s88, s76, 196608
 buffer_load_dwordx4 v5, s[52:55], s88 offen lds
 s_add_u32 m0, s77, 16384
 s_add_u32 s88, s76, 262144
 buffer_load_dwordx4 v5, s[52:55], s88 offen lds
 s_add_u32 m0, s77, 20480
 s_add_u32 s88, s76, 327680
 buffer_load_dwordx4 v5, s[52:55], s88 offen lds
 s_add_u32 m0, s77, 24576
 s_add_u32 s88, s76, 393216
 buffer_load_dwordx4 v5, s[52:55], s88 offen lds
Lhop8:
 s_cbranch_execz Lhop12
 v_and_b32 v243, 0xf0, v1
 buffer_load_ubyte v242, v243, s[32:35], 0 offen sc1
 s_add_u32 m0, s72, 0
 s_nop 0
 ds_read_addtid_b32 v96 offset:32768
 ds_read_addtid_b32 v98 offset:33024
 ds_read_addtid_b32 v100 offset:33280
 ds_read_addtid_b32 v102 offset:33536
 ds_read_addtid_b32 v97 offset:33792
 ds_read_addtid_b32 v99 offset:34048
 ds_read_addtid_b32 v101 offset:34304
 ds_read_addtid_b32 v103 offset:34560
 s_add_u32 m0, s73, 0
 s_nop 0
 ds_read_addtid_b32 v104 offset:32768
 ds_read_addtid_b32 v106 offset:33024
 ds_read_addtid_b32 v108 offset:33280
 ds_read_addtid_b32 v110 offset:33536
 ds_read_addtid_b32 v105 offset:33792
 ds_read_addtid_b32 v107 offset:34048
 ds_read_addtid_b32 v109 offset:34304
 s_waitcnt lgkmcnt(11)
 ds_read_addtid_b32 v111 offset:34560
 s_add_u32 m0, s74, 0
 s_nop 0
 ds_read_addtid_b32 v112 offset:32768
 ds_read_addtid_b32 v114 offset:33024
 ds_read_addtid_b32 v116 offset:33280
 s_waitcnt lgkmcnt(11)
 ds_read_addtid_b32 v118 offset:33536
 ds_read_addtid_b32 v113 offset:33792
 ds_read_addtid_b32 v115 offset:34048
 ds_read_addtid_b32 v117 offset:34304
 s_waitcnt lgkmcnt(11)
 ds_read_addtid_b32 v119 offset:34560
 s_add_u32 m0, s75, 0
 s_nop 0
 ds_read_addtid_b32 v120 offset:32768
 ds_read_addtid_b32 v122 offset:33024
 ds_read_addtid_b32 v124 offset:33280
 s_waitcnt lgkmcnt(11)
 ds_read_addtid_b32 v126 offset:33536
 ds_read_addtid_b32 v121 offset:33792
 ds_read_addtid_b32 v123 offset:34048
 ds_read_addtid_b32 v125 offset:34304
 s_waitcnt lgkmcnt(11)
 ds_read_addtid_b32 v127 offset:34560
 s_mov_b64 exec, 0xffff
 buffer_load_dword v14, v8, s[36:39], s11 offen sc1
 s_mov_b64 exec, 1
 buffer_load_dword v14, v8, s[28:31], s12 offen sc1
 s_mov_b64 exec, -1
 s_and_b32 s88, s67, 7
 s_lshl_b32 s88, s88, 7
 s_add_u32 s88, s88, s79
 v_lshlrev_b32_e64 v11, 6, v1
 s_mov_b64 exec, 585
 buffer_load_dword v14, v11, s[48:51], s88 offen
 s_mov_b64 exec, -1
 s_add_u32 s91, s4, 4096
 s_waitcnt vmcnt(34) lgkmcnt(0)
 s_barrier
 v_mov_b32 v250, 2
 s_waitcnt vmcnt(11)
 s_cmp_lg_u32 s63, 0
 s_cbranch_scc1 Lsl29
 s_lshl_b32 s88, s62, 2
 s_add_u32 s88, s88, s13
 s_mov_b64 exec, 1
 buffer_store_dword v250, v1, s[28:31], s88 offen
 s_mov_b64 exec, -1
Lbk30:
 s_add_u32 m0, s77, 28672
 s_add_u32 s88, s76, 458752
 buffer_load_dwordx4 v5, s[52:55], s88 offen lds
 s_add_u32 m0, s77, 32768
 s_add_u32 s88, s76, 16384
 buffer_load_dwordx4 v5, s[52:55], s88 offen lds
 s_add_u32 m0, s77, 36864
 s_add_u32 s88, s76, 81920
 buffer_load_dwordx4 v5, s[52:55], s88 offen lds
 s_add_u32 m0, s77, 40960
 s_add_u32 s88, s76, 147456
 buffer_load_dwordx4 v5, s[52:55], s88 offen lds
 s_setprio 0
 s_add_u32 s89, s72, 98304
 v_add_u32_e64 v24, s89, v2
 s_add_u32 s89, s73, 98304
 v_add_u32_e64 v32, s89, v2
 s_add_u32 s89, s74, 98304
 v_add_u32_e64 v40, s89, v2
 s_add_u32 s89, s75, 98304
 v_add_u32_e64 v48, s89, v2
 ds_read_b64_tr_b16 v[30:31], v24 offset:0
 ds_read_b64_tr_b16 v[28:29], v24 offset:512
 ds_read_b64_tr_b16 v[26:27], v24 offset:1024
 ds_read_b64_tr_b16 v[24:25], v24 offset:1536
 ds_read_b64_tr_b16 v[38:39], v32 offset:0
 ds_read_b64_tr_b16 v[36:37], v32 offset:512
 ds_read_b64_tr_b16 v[34:35], v32 offset:1024
 ds_read_b64_tr_b16 v[32:33], v32 offset:1536
 ds_read_b64_tr_b16 v[46:47], v40 offset:0
 ds_read_b64_tr_b16 v[44:45], v40 offset:512
 ds_read_b64_tr_b16 v[42:43], v40 offset:1024
 ds_read_b64_tr_b16 v[40:41], v40 offset:1536
 ds_read_b64_tr_b16 v[54:55], v48 offset:0
 ds_read_b64_tr_b16 v[52:53], v48 offset:512
 ds_read_b64_tr_b16 v[50:51], v48 offset:1024
 s_waitcnt lgkmcnt(11)
 ds_read_b64_tr_b16 v[48:49], v48 offset:1536
 v_lshrrev_b32 v16, 2, v1
 v_xor_b32_e64 v16, v16, v1
 v_bfe_u32 v16, v16, 6, 1
 v_add_u32 v16, -1, v16
 v_and_b32 v16, s94, v16
 v_mov_b32 v17, v16
 v_mov_b32 v18, v16
 v_mov_b32 v19, v16
 s_nop 0
 v_and_b32 v11, 0x1f0, v1
 s_lshl_b32 s88, s60, 2
 s_add_u32 s88, s88, 160256
 v_add_u32_e64 v11, s88, v11
 s_waitcnt lgkmcnt(0)
 s_setprio 2
 s_waitcnt lgkmcnt(14)
 v_mfma_f32_16x16x32_bf16 v[20:23], v[16:19], v[28:31], 0
 v_mfma_f32_16x16x32_bf16 v[20:23], v[16:19], v[24:27], v[20:23]
 v_mfma_f32_16x16x32_bf16 v[20:23], v[16:19], v[36:39], v[20:23]
 v_mfma_f32_16x16x32_bf16 v[20:23], v[16:19], v[32:35], v[20:23]
 v_mfma_f32_16x16x32_bf16 v[20:23], v[16:19], v[44:47], v[20:23]
 v_mfma_f32_16x16x32_bf16 v[20:23], v[16:19], v[40:43], v[20:23]
 v_mfma_f32_16x16x32_bf16 v[20:23], v[16:19], v[52:55], v[20:23]
 v_mfma_f32_16x16x32_bf16 v[20:23], v[16:19], v[48:51], v[20:23]
 s_nop 7
 ds_write_b32 v11, v20
 s_and_b32 s88, s67, 7
 s_lshl_b32 s88, s88, 7
 s_add_u32 s88, s88, s78
 v_lshlrev_b32 v11, 6, v1
 s_mov_b64 exec, 15
 buffer_load_dword v14, v11, s[56:59], s88 offen
 s_mov_b64 exec, -1
 s_waitcnt vmcnt(10) lgkmcnt(0)
 s_barrier
 s_add_u32 m0, s77, 45056
 s_add_u32 s88, s76, 212992
 buffer_load_dwordx4 v5, s[52:55], s88 offen lds
 s_add_u32 m0, s77, 49152
 s_add_u32 s88, s76, 278528
 buffer_load_dwordx4 v5, s[52:55], s88 offen lds
 s_add_u32 m0, s77, 53248
 s_add_u32 s88, s76, 344064
 buffer_load_dwordx4 v5, s[52:55], s88 offen lds
 s_add_u32 m0, s77, 57344
 s_add_u32 s88, s76, 409600
 buffer_load_dwordx4 v5, s[52:55], s88 offen lds
 s_add_u32 m0, s77, 61440
 s_add_u32 s88, s76, 475136
 buffer_load_dwordx4 v5, s[52:55], s88 offen lds
 v_and_b32 v11, 0x400, v8
 v_mad_u32_u24 v11, v11, 15, v8
 s_mov_b64 exec, 0xffff
 buffer_load_dword v14, v11, s[28:31], s10 offen sc1
 s_mov_b64 exec, 1
 buffer_load_dword v14, v8, s[28:31], s13 offen sc1
 s_mov_b64 exec, -1
 v_lshrrev_b32 v249, 2, v1
 v_and_b32_e64 v249, 60, v249
 buffer_load_dword v248, v249, s[28:31], s13 offen sc1
 s_add_u32 s88, s5, 1310720
 s_add_u32 s89, s7, 1310720
 buffer_store_dwordx2 v[224:225], v3, s[28:31], s88 offen sc1
 buffer_store_dwordx2 v[224:225], v7, s[28:31], s89 offen sc1
 s_add_u32 s88, s5, 1966080
 s_add_u32 s89, s7, 1966080
 buffer_store_dwordx2 v[224:225], v3, s[28:31], s88 offen sc1
 buffer_store_dwordx2 v[224:225], v7, s[28:31], s89 offen sc1
 s_add_u32 s89, s72, 65536
 v_add_u32_e64 v24, s89, v2
 s_add_u32 s89, s73, 65536
 v_add_u32_e64 v32, s89, v2
 s_add_u32 s89, s74, 65536
 v_add_u32_e64 v40, s89, v2
 s_add_u32 s89, s75, 65536
 v_add_u32_e64 v48, s89, v2
 ds_read_b64_tr_b16 v[30:31], v24 offset:0
 ds_read_b64_tr_b16 v[28:29], v24 offset:512
 ds_read_b64_tr_b16 v[26:27], v24 offset:1024
 ds_read_b64_tr_b16 v[24:25], v24 offset:1536
 ds_read_b64_tr_b16 v[38:39], v32 offset:0
 ds_read_b64_tr_b16 v[36:37], v32 offset:512
 ds_read_b64_tr_b16 v[34:35], v32 offset:1024
 ds_read_b64_tr_b16 v[32:33], v32 offset:1536
 ds_read_b64_tr_b16 v[46:47], v40 offset:0
 ds_read_b64_tr_b16 v[44:45], v40 offset:512
 ds_read_b64_tr_b16 v[42:43], v40 offset:1024
 ds_read_b64_tr_b16 v[40:41], v40 offset:1536
 ds_read_b64_tr_b16 v[54:55], v48 offset:0
 ds_read_b64_tr_b16 v[52:53], v48 offset:512
 ds_read_b64_tr_b16 v[50:51], v48 offset:1024
 s_waitcnt lgkmcnt(11)
 ds_read_b64_tr_b16 v[48:49], v48 offset:1536
 v_and_b32 v11, 0x1f0, v1
 s_lshl_b32 s88, s60, 2
 s_add_u32 s88, s88, 160768
 v_add_u32 v11, s88, v11
 s_waitcnt lgkmcnt(14)
 v_lshlrev_b32_e64 v20, 16, v28
 v_and_b32 v21, 0xffff0000, v28
 v_lshlrev_b32_e64 v16, 16, v29
 v_and_b32 v17, 0xffff0000, v29
 v_add_f32 v20, v20, v16
 v_add_f32 v21, v21, v17
 v_lshlrev_b32_e64 v16, 16, v30
 v_and_b32 v17, 0xffff0000, v30
 v_add_f32 v20, v20, v16
 v_add_f32 v21, v21, v17
 v_lshlrev_b32_e64 v16, 16, v31
 v_and_b32 v17, 0xffff0000, v31
 v_add_f32 v20, v20, v16
 v_add_f32 v21, v21, v17
 v_lshlrev_b32_e64 v16, 16, v24
 v_and_b32 v17, 0xffff0000, v24
 v_add_f32 v20, v20, v16
 v_add_f32 v21, v21, v17
 v_lshlrev_b32_e64 v16, 16, v25
 v_and_b32 v17, 0xffff0000, v25
 v_add_f32 v20, v20, v16
 v_add_f32 v21, v21, v17
 v_lshlrev_b32_e64 v16, 16, v26
 v_and_b32 v17, 0xffff0000, v26
 v_add_f32 v20, v20, v16
 v_add_f32 v21, v21, v17
 v_lshlrev_b32_e64 v16, 16, v27
 v_and_b32 v17, 0xffff0000, v27
 v_add_f32 v20, v20, v16
 v_add_f32 v21, v21, v17
 s_waitcnt lgkmcnt(10)
 v_lshlrev_b32 v16, 16, v36
 v_and_b32 v17, 0xffff0000, v36
 v_add_f32 v20, v20, v16
 v_add_f32 v21, v21, v17
 v_lshlrev_b32_e64 v16, 16, v37
 v_and_b32 v17, 0xffff0000, v37
 v_add_f32 v20, v20, v16
 v_add_f32 v21, v21, v17
 v_lshlrev_b32_e64 v16, 16, v38
 v_and_b32 v17, 0xffff0000, v38
 v_add_f32 v20, v20, v16
 v_add_f32 v21, v21, v17
 v_lshlrev_b32_e64 v16, 16, v39
 v_and_b32 v17, 0xffff0000, v39
 v_add_f32 v20, v20, v16
 v_add_f32 v21, v21, v17
 s_waitcnt lgkmcnt(8)
 v_lshlrev_b32 v16, 16, v32
 v_and_b32 v17, 0xffff0000, v32
 v_add_f32 v20, v20, v16
 v_add_f32 v21, v21, v17
 v_lshlrev_b32_e64 v16, 16, v33
 v_and_b32 v17, 0xffff0000, v33
 v_add_f32 v20, v20, v16
 v_add_f32 v21, v21, v17
 v_lshlrev_b32_e64 v16, 16, v34
 v_and_b32 v17, 0xffff0000, v34
 v_add_f32 v20, v20, v16
 v_add_f32 v21, v21, v17
 v_lshlrev_b32_e64 v16, 16, v35
 v_and_b32 v17, 0xffff0000, v35
 v_add_f32 v20, v20, v16
 v_add_f32 v21, v21, v17
 s_waitcnt lgkmcnt(6)
 v_lshlrev_b32 v16, 16, v44
 v_and_b32 v17, 0xffff0000, v44
 v_add_f32 v20, v20, v16
 v_add_f32 v21, v21, v17
 v_lshlrev_b32_e64 v16, 16, v45
 v_and_b32 v17, 0xffff0000, v45
 v_add_f32 v20, v20, v16
 v_add_f32 v21, v21, v17
 v_lshlrev_b32_e64 v16, 16, v46
 v_and_b32 v17, 0xffff0000, v46
 v_add_f32 v20, v20, v16
 v_add_f32 v21, v21, v17
 v_lshlrev_b32_e64 v16, 16, v47
 v_and_b32 v17, 0xffff0000, v47
 v_add_f32 v20, v20, v16
 v_add_f32 v21, v21, v17
 s_waitcnt lgkmcnt(4)
 v_lshlrev_b32 v16, 16, v40
 v_and_b32 v17, 0xffff0000, v40
 v_add_f32 v20, v20, v16
 v_add_f32 v21, v21, v17
 v_lshlrev_b32_e64 v16, 16, v41
 v_and_b32 v17, 0xffff0000, v41
 v_add_f32 v20, v20, v16
 v_add_f32 v21, v21, v17
 v_lshlrev_b32_e64 v16, 16, v42
 v_and_b32 v17, 0xffff0000, v42
 v_add_f32 v20, v20, v16
 v_add_f32 v21, v21, v17
 v_lshlrev_b32_e64 v16, 16, v43
 v_and_b32 v17, 0xffff0000, v43
 v_add_f32 v20, v20, v16
 v_add_f32 v21, v21, v17
 s_waitcnt lgkmcnt(2)
 v_lshlrev_b32 v16, 16, v52
 v_and_b32 v17, 0xffff0000, v52
 v_add_f32 v20, v20, v16
 v_add_f32 v21, v21, v17
 v_lshlrev_b32_e64 v16, 16, v53
 v_and_b32 v17, 0xffff0000, v53
 v_add_f32 v20, v20, v16
 v_add_f32 v21, v21, v17
Lhop9:
 s_cbranch_execz Lhop13
 v_lshlrev_b32 v16, 16, v54
 v_and_b32 v17, 0xffff0000, v54
 v_add_f32 v20, v20, v16
 v_add_f32 v21, v21, v17
 v_lshlrev_b32_e64 v16, 16, v55
 v_and_b32 v17, 0xffff0000, v55
 v_add_f32 v20, v20, v16
 v_add_f32 v21, v21, v17
 s_waitcnt lgkmcnt(0)
 v_lshlrev_b32 v16, 16, v48
 v_and_b32 v17, 0xffff0000, v48
 v_add_f32 v20, v20, v16
 v_add_f32 v21, v21, v17
 v_lshlrev_b32_e64 v16, 16, v49
 v_and_b32 v17, 0xffff0000, v49
 v_add_f32 v20, v20, v16
 v_add_f32 v21, v21, v17
 v_lshlrev_b32_e64 v16, 16, v50
 v_and_b32 v17, 0xffff0000, v50
 v_add_f32 v20, v20, v16
 v_add_f32 v21, v21, v17
 v_lshlrev_b32_e64 v16, 16, v51
 v_and_b32 v17, 0xffff0000, v51
 v_add_f32 v20, v20, v16
 v_add_f32 v21, v21, v17
 v_add_f32 v16, v20, v21
 v_add_f32 v20, v20, v21
 s_nop 1
 v_permlane32_swap_b32 v20, v16
 v_add_f32_e64 v20, v20, v16
 ds_write_b32 v11, v20
 v_lshlrev_b32_e64 v11, 6, v1
 s_mov_b64 exec, 585
 buffer_load_dword v14, v11, s[48:51], s79 offen offset:384
 s_mov_b64 exec, -1
 s_waitcnt vmcnt(22)
 s_mov_b32 s66, 0
Lgchk:
 v_and_b32 v242, 0x40, v242
 v_cmp_eq_u32_e64 vcc, 0, v242
 s_cbranch_vccnz Lgchk2
 s_waitcnt vmcnt(8)
 buffer_load_dwordx2 v[48:49], v15, s[28:31], s6 offen sc1
 buffer_load_dwordx4 v[16:19], v4, s[28:31], s4 offen offset:0 sc1
 buffer_load_dwordx4 v[20:23], v4, s[28:31], s4 offen offset:256 sc1
 buffer_load_dwordx4 v[24:27], v4, s[28:31], s4 offen offset:2048 sc1
 buffer_load_dwordx4 v[28:31], v4, s[28:31], s4 offen offset:2304 sc1
 buffer_load_dwordx4 v[32:35], v4, s[28:31], s91 offen offset:0 sc1
 buffer_load_dwordx4 v[36:39], v4, s[28:31], s91 offen offset:256 sc1
 buffer_load_dwordx4 v[40:43], v4, s[28:31], s91 offen offset:2048 sc1
 buffer_load_dwordx4 v[44:47], v4, s[28:31], s91 offen offset:2304 sc1
Lsk0:
 v_mov_b32 v50, 0
 v_mov_b32 v51, 0
 s_add_u32 m0, s72, 34564
 s_nop 0
 ds_read_addtid_b32 v128 offset:63740
 ds_read_addtid_b32 v130 offset:63996
 ds_read_addtid_b32 v132 offset:64252
 ds_read_addtid_b32 v134 offset:64508
 ds_read_addtid_b32 v129 offset:64764
 ds_read_addtid_b32 v131 offset:65020
 ds_read_addtid_b32 v133 offset:65276
 ds_read_addtid_b32 v135 offset:65532
 s_add_u32 m0, s73, 34564
 s_nop 0
 ds_read_addtid_b32 v136 offset:63740
 ds_read_addtid_b32 v138 offset:63996
 ds_read_addtid_b32 v140 offset:64252
 ds_read_addtid_b32 v142 offset:64508
 ds_read_addtid_b32 v137 offset:64764
 ds_read_addtid_b32 v139 offset:65020
 s_waitcnt lgkmcnt(11)
 ds_read_addtid_b32 v141 offset:65276
 ds_read_addtid_b32 v143 offset:65532
 s_add_u32 m0, s74, 34564
 s_nop 0
 ds_read_addtid_b32 v144 offset:63740
 ds_read_addtid_b32 v146 offset:63996
 s_waitcnt lgkmcnt(11)
 ds_read_addtid_b32 v148 offset:64252
 ds_read_addtid_b32 v150 offset:64508
 ds_read_addtid_b32 v145 offset:64764
 ds_read_addtid_b32 v147 offset:65020
 s_waitcnt lgkmcnt(11)
 ds_read_addtid_b32 v149 offset:65276
 ds_read_addtid_b32 v151 offset:65532
 s_add_u32 m0, s75, 34564
 s_nop 0
 ds_read_addtid_b32 v152 offset:63740
 ds_read_addtid_b32 v154 offset:63996
 s_waitcnt lgkmcnt(11)
 ds_read_addtid_b32 v156 offset:64252
 ds_read_addtid_b32 v158 offset:64508
 ds_read_addtid_b32 v153 offset:64764
 ds_read_addtid_b32 v155 offset:65020
 s_waitcnt lgkmcnt(11)
 ds_read_addtid_b32 v157 offset:65276
 ds_read_addtid_b32 v159 offset:65532
 s_waitcnt vmcnt(8)
 v_mov_b32_e64 v10, v48
 v_mfma_f32_16x16x32_bf16 v[48:51], v[56:59], v[48:51], 0
 s_waitcnt vmcnt(7)
 v_mfma_f32_16x16x32_bf16 v[52:55], v[56:59], v[16:19], 0
 s_waitcnt vmcnt(6)
 v_mfma_f32_16x16x32_bf16 v[52:55], v[60:63], v[20:23], v[52:55]
 s_waitcnt vmcnt(5)
 v_mfma_f32_16x16x32_bf16 v[52:55], v[56:59], v[24:27], v[52:55]
 s_waitcnt vmcnt(4)
 v_mfma_f32_16x16x32_bf16 v[52:55], v[60:63], v[28:31], v[52:55]
 v_add_f32_dpp v48, v48, v48 row_ror:4 row_mask:0xf bank_mask:0xf
 s_waitcnt vmcnt(3)
 v_mfma_f32_16x16x32_bf16 v[52:55], v[56:59], v[32:35], v[52:55]
 v_add_f32_dpp v49, v49, v49 row_ror:4 row_mask:0xf bank_mask:0xf
 s_waitcnt vmcnt(2)
 v_mfma_f32_16x16x32_bf16 v[52:55], v[60:63], v[36:39], v[52:55]
 v_add_f32_dpp v50, v50, v50 row_ror:4 row_mask:0xf bank_mask:0xf
 s_waitcnt vmcnt(1)
 v_mfma_f32_16x16x32_bf16 v[52:55], v[56:59], v[40:43], v[52:55]
 v_add_f32_dpp v51, v51, v51 row_ror:4 row_mask:0xf bank_mask:0xf
 s_waitcnt vmcnt(0)
 v_mfma_f32_16x16x32_bf16 v[52:55], v[60:63], v[44:47], v[52:55]
 v_add_f32_dpp v48, v48, v48 row_ror:8 row_mask:0xf bank_mask:0xf
 v_add_f32_dpp v49, v49, v49 row_ror:8 row_mask:0xf bank_mask:0xf
 v_add_f32_dpp v50, v50, v50 row_ror:8 row_mask:0xf bank_mask:0xf
 v_add_f32_dpp v51, v51, v51 row_ror:8 row_mask:0xf bank_mask:0xf
 v_cvt_pk_bf16_f32 v48, v48, v49
 v_cvt_pk_bf16_f32 v49, v50, v51
 ds_write_b64 v13, v[48:49]
 s_nop 0
 v_cvt_pk_bf16_f32 v52, v52, v53
 v_cvt_pk_bf16_f32 v53, v54, v55
 ds_write_b64 v12, v[52:53]
 v_cmp_u_f32 vcc, v51, v55
 s_cbranch_vccnz Lkr0
Lkb0:
Lc2:
 v_cmp_eq_u32_e64 vcc, -1, v248
 s_cbranch_vccnz Lc2r
 s_add_u32 s88, s68, 2048
 buffer_load_dwordx4 v[192:195], v6, s[48:51], s88 offen
 s_add_u32 s88, s68, 51200
 buffer_load_dwordx4 v[196:199], v6, s[48:51], s88 offen
 s_add_u32 s88, s69, 2048
 buffer_load_dwordx4 v[200:203], v6, s[48:51], s88 offen
 s_add_u32 s88, s69, 51200
 buffer_load_dwordx4 v[204:207], v6, s[48:51], s88 offen
 s_add_u32 s88, s70, 2048
 buffer_load_dwordx4 v[208:211], v6, s[48:51], s88 offen
 s_add_u32 s88, s70, 51200
 buffer_load_dwordx4 v[212:215], v6, s[48:51], s88 offen
 s_add_u32 s88, s71, 2048
 buffer_load_dwordx4 v[216:219], v6, s[48:51], s88 offen
 s_add_u32 s88, s71, 51200
 buffer_load_dwordx4 v[220:223], v6, s[48:51], s88 offen
 s_waitcnt lgkmcnt(0)
 s_barrier
 s_setprio 0
 s_waitcnt vmcnt(0)
 s_add_u32 s89, s72, 98304
 v_add_u32_e64 v11, s89, v1
 ds_write_b128 v11, v[192:195] offset:0
 ds_write_b128 v11, v[196:199] offset:1024
 s_add_u32 s89, s73, 98304
 v_add_u32_e64 v11, s89, v1
 ds_write_b128 v11, v[200:203] offset:0
 ds_write_b128 v11, v[204:207] offset:1024
 s_add_u32 s89, s74, 98304
 v_add_u32_e64 v11, s89, v1
 ds_write_b128 v11, v[208:211] offset:0
 ds_write_b128 v11, v[212:215] offset:1024
 s_add_u32 s89, s75, 98304
 v_add_u32_e64 v11, s89, v1
 ds_write_b128 v11, v[216:219] offset:0
 ds_write_b128 v11, v[220:223] offset:1024
 s_waitcnt lgkmcnt(0)
 s_add_u32 m0, s72, 34564
 s_nop 0
 ds_read_addtid_b32 v192 offset:63740
 ds_read_addtid_b32 v193 offset:63996
 ds_read_addtid_b32 v194 offset:64252
 ds_read_addtid_b32 v195 offset:64508
 ds_read_addtid_b32 v196 offset:64764
 ds_read_addtid_b32 v197 offset:65020
 ds_read_addtid_b32 v198 offset:65276
 ds_read_addtid_b32 v199 offset:65532
 s_add_u32 m0, s73, 34564
 s_nop 0
 ds_read_addtid_b32 v200 offset:63740
 ds_read_addtid_b32 v201 offset:63996
 ds_read_addtid_b32 v202 offset:64252
 ds_read_addtid_b32 v203 offset:64508
 ds_read_addtid_b32 v204 offset:64764
 ds_read_addtid_b32 v205 offset:65020
 ds_read_addtid_b32 v206 offset:65276
 s_waitcnt lgkmcnt(11)
 ds_read_addtid_b32 v207 offset:65532
 s_add_u32 m0, s74, 34564
 s_nop 0
 ds_read_addtid_b32 v208 offset:63740
 ds_read_addtid_b32 v209 offset:63996
 ds_read_addtid_b32 v210 offset:64252
 s_waitcnt lgkmcnt(11)
 ds_read_addtid_b32 v211 offset:64508
 ds_read_addtid_b32 v212 offset:64764
 ds_read_addtid_b32 v213 offset:65020
 ds_read_addtid_b32 v214 offset:65276
 s_waitcnt lgkmcnt(11)
 ds_read_addtid_b32 v215 offset:65532
 s_add_u32 m0, s75, 34564
 s_nop 0
 ds_read_addtid_b32 v216 offset:63740
 ds_read_addtid_b32 v217 offset:63996
 ds_read_addtid_b32 v218 offset:64252
 s_waitcnt lgkmcnt(11)
 ds_read_addtid_b32 v219 offset:64508
 ds_read_addtid_b32 v220 offset:64764
 ds_read_addtid_b32 v221 offset:65020
 ds_read_addtid_b32 v222 offset:65276
 s_waitcnt lgkmcnt(11)
 ds_read_addtid_b32 v223 offset:65532
 s_waitcnt lgkmcnt(0)
 s_add_u32 s89, s72, 98304
 v_add_u32 v24, s89, v2
 s_add_u32 s89, s73, 98304
 v_add_u32_e64 v32, s89, v2
 ds_read_b64_tr_b16 v[30:31], v24 offset:0
 ds_read_b64_tr_b16 v[28:29], v24 offset:512
 ds_read_b64_tr_b16 v[26:27], v24 offset:1024
 ds_read_b64_tr_b16 v[24:25], v24 offset:1536
 ds_read_b64_tr_b16 v[38:39], v32 offset:0
 ds_read_b64_tr_b16 v[36:37], v32 offset:512
 ds_read_b64_tr_b16 v[34:35], v32 offset:1024
 ds_read_b64_tr_b16 v[32:33], v32 offset:1536
 v_lshrrev_b32 v16, 2, v1
 v_xor_b32 v16, v16, v1
 v_bfe_u32 v16, v16, 6, 1
 v_add_u32 v16, -1, v16
 v_and_b32 v16, s94, v16
 v_mov_b32 v17, v16
 v_mov_b32 v18, v16
 v_mov_b32_e64 v19, v16
 s_nop 0
 s_waitcnt lgkmcnt(6)
 v_mfma_f32_16x16x32_bf16 v[20:23], v[16:19], v[28:31], 0
 s_waitcnt lgkmcnt(4)
 v_mfma_f32_16x16x32_bf16 v[20:23], v[16:19], v[24:27], v[20:23]
 s_waitcnt lgkmcnt(2)
 v_mfma_f32_16x16x32_bf16 v[20:23], v[16:19], v[36:39], v[20:23]
 s_waitcnt lgkmcnt(0)
 v_mfma_f32_16x16x32_bf16 v[20:23], v[16:19], v[32:35], v[20:23]
 s_add_u32 s89, s74, 98304
 v_add_u32 v40, s89, v2
 s_add_u32 s89, s75, 98304
 v_add_u32_e64 v48, s89, v2
 ds_read_b64_tr_b16 v[46:47], v40 offset:0
 ds_read_b64_tr_b16 v[44:45], v40 offset:512
 ds_read_b64_tr_b16 v[42:43], v40 offset:1024
 ds_read_b64_tr_b16 v[40:41], v40 offset:1536
 ds_read_b64_tr_b16 v[54:55], v48 offset:0
 ds_read_b64_tr_b16 v[52:53], v48 offset:512
 ds_read_b64_tr_b16 v[50:51], v48 offset:1024
 ds_read_b64_tr_b16 v[48:49], v48 offset:1536
 v_and_b32 v11, 0x1f0, v1
 s_lshl_b32 s88, s60, 2
 s_add_u32 s88, s88, 161280
 v_add_u32_e64 v11, s88, v11
 s_waitcnt lgkmcnt(6)
 v_mfma_f32_16x16x32_bf16 v[20:23], v[16:19], v[44:47], v[20:23]
 s_waitcnt lgkmcnt(4)
 v_mfma_f32_16x16x32_bf16 v[20:23], v[16:19], v[40:43], v[20:23]
 s_waitcnt lgkmcnt(2)
 v_mfma_f32_16x16x32_bf16 v[20:23], v[16:19], v[52:55], v[20:23]
 s_waitcnt lgkmcnt(0)
 v_mfma_f32_16x16x32_bf16 v[20:23], v[16:19], v[48:51], v[20:23]
 s_nop 7
 ds_write_b32 v11, v20
 s_waitcnt lgkmcnt(0)
 s_barrier
 s_setprio 0
 s_add_u32 m0, s72, 34564
 s_nop 0
 ds_read_addtid_b32 v160 offset:30972
 ds_read_addtid_b32 v161 offset:31228
 ds_read_addtid_b32 v162 offset:31484
 ds_read_addtid_b32 v163 offset:31740
 ds_read_addtid_b32 v164 offset:31996
 ds_read_addtid_b32 v165 offset:32252
 ds_read_addtid_b32 v166 offset:32508
 ds_read_addtid_b32 v167 offset:32764
 s_add_u32 m0, s73, 34564
 s_nop 0
 ds_read_addtid_b32 v168 offset:30972
 ds_read_addtid_b32 v169 offset:31228
 ds_read_addtid_b32 v170 offset:31484
 ds_read_addtid_b32 v171 offset:31740
 ds_read_addtid_b32 v172 offset:31996
 ds_read_addtid_b32 v173 offset:32252
 ds_read_addtid_b32 v174 offset:32508
Lhop10:
 s_cbranch_execz Lhop14
 s_waitcnt lgkmcnt(11)
 ds_read_addtid_b32 v175 offset:32764
 s_add_u32 m0, s74, 34564
 s_nop 0
 ds_read_addtid_b32 v176 offset:30972
 ds_read_addtid_b32 v177 offset:31228
 ds_read_addtid_b32 v178 offset:31484
 s_waitcnt lgkmcnt(11)
 ds_read_addtid_b32 v179 offset:31740
 ds_read_addtid_b32 v180 offset:31996
 ds_read_addtid_b32 v181 offset:32252
 ds_read_addtid_b32 v182 offset:32508
 s_waitcnt lgkmcnt(11)
 ds_read_addtid_b32 v183 offset:32764
 s_add_u32 m0, s75, 34564
 s_nop 0
 ds_read_addtid_b32 v184 offset:30972
 ds_read_addtid_b32 v185 offset:31228
 ds_read_addtid_b32 v186 offset:31484
 s_waitcnt lgkmcnt(11)
 ds_read_addtid_b32 v187 offset:31740
 ds_read_addtid_b32 v188 offset:31996
 ds_read_addtid_b32 v189 offset:32252
 ds_read_addtid_b32 v190 offset:32508
 s_waitcnt lgkmcnt(11)
 ds_read_addtid_b32 v191 offset:32764
 s_add_u32 m0, s72, 0
 s_nop 0
 ds_write_addtid_b32 v64 offset:0
 ds_write_addtid_b32 v65 offset:256
 ds_write_addtid_b32 v66 offset:512
 s_waitcnt lgkmcnt(11)
 ds_write_addtid_b32 v67 offset:768
 ds_write_addtid_b32 v68 offset:1024
 ds_write_addtid_b32 v69 offset:1280
 ds_write_addtid_b32 v70 offset:1536
 s_waitcnt lgkmcnt(11)
 ds_write_addtid_b32 v71 offset:1792
 s_add_u32 m0, s73, 0
 s_nop 0
 ds_write_addtid_b32 v72 offset:0
 ds_write_addtid_b32 v73 offset:256
 ds_write_addtid_b32 v74 offset:512
 s_waitcnt lgkmcnt(11)
 ds_write_addtid_b32 v75 offset:768
 ds_write_addtid_b32 v76 offset:1024
 ds_write_addtid_b32 v77 offset:1280
 ds_write_addtid_b32 v78 offset:1536
 s_waitcnt lgkmcnt(11)
 ds_write_addtid_b32 v79 offset:1792
 s_add_u32 m0, s74, 0
 s_nop 0
 ds_write_addtid_b32 v80 offset:0
 ds_write_addtid_b32 v81 offset:256
 ds_write_addtid_b32 v82 offset:512
 s_waitcnt lgkmcnt(11)
 ds_write_addtid_b32 v83 offset:768
 ds_write_addtid_b32 v84 offset:1024
 ds_write_addtid_b32 v85 offset:1280
 ds_write_addtid_b32 v86 offset:1536
 s_waitcnt lgkmcnt(11)
 ds_write_addtid_b32 v87 offset:1792
 s_add_u32 m0, s75, 0
 s_nop 0
 ds_write_addtid_b32 v88 offset:0
 ds_write_addtid_b32 v89 offset:256
 ds_write_addtid_b32 v90 offset:512
 s_waitcnt lgkmcnt(11)
 ds_write_addtid_b32 v91 offset:768
 ds_write_addtid_b32 v92 offset:1024
 ds_write_addtid_b32 v93 offset:1280
 ds_write_addtid_b32 v94 offset:1536
 s_waitcnt lgkmcnt(11)
 ds_write_addtid_b32 v95 offset:1792
 v_mov_b32 v11, 131072
 s_setprio 2
 s_waitcnt lgkmcnt(0)
 s_mov_b64 exec, 1
 ds_add_u32 v11, v11 offset:31232
 s_mov_b64 exec, -1
 s_branch Lhy32
Lhx31:
 s_sub_u32 s64, s64, 1
 s_cbranch_scc1 Lexit2
 s_sleep 1
Lhy32:
 ds_read_b32 v10, v11 offset:31232
 s_waitcnt lgkmcnt(0)
 v_readfirstlane_b32 s90, v10
 s_cmp_lt_u32 s90, 2097152
 s_cbranch_scc1 Lhx31
 s_add_u32 m0, s72, 32768
 s_add_u32 s88, s68, 0
 buffer_load_dwordx4 v6, s[48:51], s88 offen lds
 s_add_u32 m0, s72, 33792
 s_add_u32 s88, s68, 49152
 buffer_load_dwordx4 v6, s[48:51], s88 offen lds
 s_add_u32 m0, s73, 32768
 s_add_u32 s88, s69, 0
 buffer_load_dwordx4 v6, s[48:51], s88 offen lds
 s_add_u32 m0, s73, 33792
 s_add_u32 s88, s69, 49152
 buffer_load_dwordx4 v6, s[48:51], s88 offen lds
 s_add_u32 m0, s74, 32768
 s_add_u32 s88, s70, 0
 buffer_load_dwordx4 v6, s[48:51], s88 offen lds
 s_add_u32 m0, s74, 33792
 s_add_u32 s88, s70, 49152
 buffer_load_dwordx4 v6, s[48:51], s88 offen lds
 s_add_u32 m0, s75, 32768
 s_add_u32 s88, s71, 0
 buffer_load_dwordx4 v6, s[48:51], s88 offen lds
 s_add_u32 m0, s75, 33792
 s_add_u32 s88, s71, 49152
 buffer_load_dwordx4 v6, s[48:51], s88 offen lds
 s_add_u32 m0, s77, 65536
 s_add_u32 s88, s76, 0
 buffer_load_dwordx4 v5, s[56:59], s88 offen lds
 s_add_u32 m0, s77, 69632
 s_add_u32 s88, s76, 65536
 buffer_load_dwordx4 v5, s[56:59], s88 offen lds
 s_add_u32 m0, s77, 73728
 s_add_u32 s88, s76, 131072
 buffer_load_dwordx4 v5, s[56:59], s88 offen lds
 s_add_u32 s4, s4, 655360
 s_add_u32 s6, s6, 655360
 s_add_u32 s91, s4, 4096
 s_barrier
 s_add_u32 m0, s77, 77824
 s_add_u32 s88, s76, 196608
 buffer_load_dwordx4 v5, s[56:59], s88 offen lds
 s_add_u32 m0, s77, 81920
 s_add_u32 s88, s76, 262144
 buffer_load_dwordx4 v5, s[56:59], s88 offen lds
 s_add_u32 m0, s77, 86016
 s_add_u32 s88, s76, 327680
 buffer_load_dwordx4 v5, s[56:59], s88 offen lds
 s_add_u32 m0, s77, 90112
 s_add_u32 s88, s76, 393216
 buffer_load_dwordx4 v5, s[56:59], s88 offen lds
 s_waitcnt vmcnt(7)
 s_add_u32 s89, s72, 32768
 v_add_u32 v24, s89, v2
 s_add_u32 s89, s73, 32768
 v_add_u32_e64 v32, s89, v2
 s_add_u32 s89, s74, 32768
 v_add_u32_e64 v40, s89, v2
 s_add_u32 s89, s75, 32768
 v_add_u32_e64 v48, s89, v2
 ds_read_b64_tr_b16 v[30:31], v24 offset:0
 ds_read_b64_tr_b16 v[28:29], v24 offset:512
 ds_read_b64_tr_b16 v[26:27], v24 offset:1024
 ds_read_b64_tr_b16 v[24:25], v24 offset:1536
 ds_read_b64_tr_b16 v[38:39], v32 offset:0
 ds_read_b64_tr_b16 v[36:37], v32 offset:512
 ds_read_b64_tr_b16 v[34:35], v32 offset:1024
 ds_read_b64_tr_b16 v[32:33], v32 offset:1536
 ds_read_b64_tr_b16 v[46:47], v40 offset:0
 ds_read_b64_tr_b16 v[44:45], v40 offset:512
 ds_read_b64_tr_b16 v[42:43], v40 offset:1024
 ds_read_b64_tr_b16 v[40:41], v40 offset:1536
 ds_read_b64_tr_b16 v[54:55], v48 offset:0
 ds_read_b64_tr_b16 v[52:53], v48 offset:512
 ds_read_b64_tr_b16 v[50:51], v48 offset:1024
 s_waitcnt lgkmcnt(11)
 ds_read_b64_tr_b16 v[48:49], v48 offset:1536
 v_lshrrev_b32 v16, 2, v1
 v_xor_b32_e64 v16, v16, v1
 v_bfe_u32 v16, v16, 6, 1
 v_add_u32 v16, -1, v16
 v_and_b32 v16, s94, v16
 v_mov_b32 v17, v16
 v_mov_b32 v18, v16
 v_mov_b32 v19, v16
 s_nop 0
 v_and_b32 v11, 0x1f0, v1
 s_lshl_b32 s88, s60, 2
 s_add_u32 s88, s88, 161792
 v_add_u32_e64 v11, s88, v11
 s_waitcnt lgkmcnt(14)
 v_mfma_f32_16x16x32_bf16 v[20:23], v[16:19], v[28:31], 0
 v_mfma_f32_16x16x32_bf16 v[20:23], v[16:19], v[24:27], v[20:23]
 s_waitcnt lgkmcnt(10)
 v_mfma_f32_16x16x32_bf16 v[20:23], v[16:19], v[36:39], v[20:23]
 s_waitcnt lgkmcnt(8)
 v_mfma_f32_16x16x32_bf16 v[20:23], v[16:19], v[32:35], v[20:23]
 s_waitcnt lgkmcnt(6)
 v_mfma_f32_16x16x32_bf16 v[20:23], v[16:19], v[44:47], v[20:23]
 s_waitcnt lgkmcnt(4)
 v_mfma_f32_16x16x32_bf16 v[20:23], v[16:19], v[40:43], v[20:23]
 s_waitcnt lgkmcnt(2)
 v_mfma_f32_16x16x32_bf16 v[20:23], v[16:19], v[52:55], v[20:23]
 s_waitcnt lgkmcnt(0)
 v_mfma_f32_16x16x32_bf16 v[20:23], v[16:19], v[48:51], v[20:23]
 s_nop 7
 ds_write_b32 v11, v20
 s_waitcnt vmcnt(0) lgkmcnt(0)
 s_barrier
 s_add_u32 m0, s77, 94208
 s_add_u32 s88, s76, 458752
 buffer_load_dwordx4 v5, s[56:59], s88 offen lds
 s_add_u32 m0, s77, 98304
 s_add_u32 s88, s76, 16384
 buffer_load_dwordx4 v5, s[56:59], s88 offen lds
 s_add_u32 m0, s77, 102400
 s_add_u32 s88, s76, 81920
 buffer_load_dwordx4 v5, s[56:59], s88 offen lds
 s_add_u32 m0, s77, 106496
 s_add_u32 s88, s76, 147456
 buffer_load_dwordx4 v5, s[56:59], s88 offen lds
 s_add_u32 m0, s77, 110592
 s_add_u32 s88, s76, 212992
 buffer_load_dwordx4 v5, s[56:59], s88 offen lds
 s_add_u32 m0, s77, 114688
 s_add_u32 s88, s76, 278528
 buffer_load_dwordx4 v5, s[56:59], s88 offen lds
 s_add_u32 m0, s77, 118784
 s_add_u32 s88, s76, 344064
 buffer_load_dwordx4 v5, s[56:59], s88 offen lds
 s_add_u32 m0, s77, 122880
 s_add_u32 s88, s76, 409600
 buffer_load_dwordx4 v5, s[56:59], s88 offen lds
 s_add_u32 m0, s77, 126976
 s_add_u32 s88, s76, 475136
 buffer_load_dwordx4 v5, s[56:59], s88 offen lds
 buffer_load_dwordx2 v[48:49], v15, s[28:31], s6 offen sc1
 buffer_load_dwordx4 v[16:19], v4, s[28:31], s4 offen offset:0 sc1
 buffer_load_dwordx4 v[20:23], v4, s[28:31], s4 offen offset:256 sc1
 buffer_load_dwordx4 v[24:27], v4, s[28:31], s4 offen offset:2048 sc1
 buffer_load_dwordx4 v[28:31], v4, s[28:31], s4 offen offset:2304 sc1
 buffer_load_dwordx4 v[32:35], v4, s[28:31], s91 offen offset:0 sc1
 buffer_load_dwordx4 v[36:39], v4, s[28:31], s91 offen offset:256 sc1
 buffer_load_dwordx4 v[40:43], v4, s[28:31], s91 offen offset:2048 sc1
 buffer_load_dwordx4 v[44:47], v4, s[28:31], s91 offen offset:2304 sc1
Lsk1:
 v_mov_b32 v50, 0
 v_mov_b32_e64 v51, 0
 s_add_u32 m0, s72, 0
 s_nop 0
 ds_read_addtid_b32 v224 offset:32768
 ds_read_addtid_b32 v225 offset:33024
 ds_read_addtid_b32 v226 offset:33280
 ds_read_addtid_b32 v227 offset:33536
 ds_read_addtid_b32 v228 offset:33792
 ds_read_addtid_b32 v229 offset:34048
 ds_read_addtid_b32 v230 offset:34304
 ds_read_addtid_b32 v231 offset:34560
 s_add_u32 m0, s73, 0
 s_nop 0
 ds_read_addtid_b32 v232 offset:32768
 ds_read_addtid_b32 v233 offset:33024
 ds_read_addtid_b32 v234 offset:33280
 ds_read_addtid_b32 v235 offset:33536
 ds_read_addtid_b32 v236 offset:33792
 ds_read_addtid_b32 v237 offset:34048
 ds_read_addtid_b32 v238 offset:34304
 s_waitcnt lgkmcnt(11)
 ds_read_addtid_b32 v239 offset:34560
 s_add_u32 m0, s74, 0
 s_nop 0
 ds_read_addtid_b32 v240 offset:32768
 ds_read_addtid_b32 v241 offset:33024
 ds_read_addtid_b32 v242 offset:33280
 s_waitcnt lgkmcnt(11)
 ds_read_addtid_b32 v243 offset:33536
 ds_read_addtid_b32 v244 offset:33792
 ds_read_addtid_b32 v245 offset:34048
 ds_read_addtid_b32 v246 offset:34304
 s_waitcnt lgkmcnt(11)
 ds_read_addtid_b32 v247 offset:34560
 s_add_u32 m0, s75, 0
 s_nop 0
 ds_read_addtid_b32 v248 offset:32768
 ds_read_addtid_b32 v249 offset:33024
 ds_read_addtid_b32 v250 offset:33280
 s_waitcnt lgkmcnt(11)
 ds_read_addtid_b32 v251 offset:33536
 ds_read_addtid_b32 v252 offset:33792
 ds_read_addtid_b32 v253 offset:34048
 ds_read_addtid_b32 v254 offset:34304
 s_waitcnt lgkmcnt(11)
 ds_read_addtid_b32 v255 offset:34560
 s_waitcnt vmcnt(8)
 v_mov_b32_e64 v10, v48
 v_mfma_f32_16x16x32_bf16 v[48:51], v[56:59], v[48:51], 0
 s_waitcnt vmcnt(7)
 v_mfma_f32_16x16x32_bf16 v[52:55], v[56:59], v[16:19], 0
 s_waitcnt vmcnt(6)
 v_mfma_f32_16x16x32_bf16 v[52:55], v[60:63], v[20:23], v[52:55]
 s_waitcnt vmcnt(5)
 v_mfma_f32_16x16x32_bf16 v[52:55], v[56:59], v[24:27], v[52:55]
 s_waitcnt vmcnt(4)
 v_mfma_f32_16x16x32_bf16 v[52:55], v[60:63], v[28:31], v[52:55]
 v_add_f32_dpp v48, v48, v48 row_ror:4 row_mask:0xf bank_mask:0xf
 s_waitcnt vmcnt(3)
 v_mfma_f32_16x16x32_bf16 v[52:55], v[56:59], v[32:35], v[52:55]
 v_add_f32_dpp v49, v49, v49 row_ror:4 row_mask:0xf bank_mask:0xf
 s_waitcnt vmcnt(2)
 v_mfma_f32_16x16x32_bf16 v[52:55], v[60:63], v[36:39], v[52:55]
Lhop11:
 s_cbranch_execz Lhopret
 v_add_f32_dpp v50, v50, v50 row_ror:4 row_mask:0xf bank_mask:0xf
 s_waitcnt vmcnt(1)
 v_mfma_f32_16x16x32_bf16 v[52:55], v[56:59], v[40:43], v[52:55]
 v_add_f32_dpp v51, v51, v51 row_ror:4 row_mask:0xf bank_mask:0xf
 s_waitcnt vmcnt(0)
 v_mfma_f32_16x16x32_bf16 v[52:55], v[60:63], v[44:47], v[52:55]
 v_add_f32_dpp v48, v48, v48 row_ror:8 row_mask:0xf bank_mask:0xf
 v_add_f32_dpp v49, v49, v49 row_ror:8 row_mask:0xf bank_mask:0xf
 v_add_f32_dpp v50, v50, v50 row_ror:8 row_mask:0xf bank_mask:0xf
 v_add_f32_dpp v51, v51, v51 row_ror:8 row_mask:0xf bank_mask:0xf
 v_cvt_pk_bf16_f32 v48, v48, v49
 v_cvt_pk_bf16_f32 v49, v50, v51
 ds_write_b64 v13, v[48:49]
 s_nop 0
 v_cvt_pk_bf16_f32 v52, v52, v53
 v_cvt_pk_bf16_f32 v53, v54, v55
 ds_write_b64 v12, v[52:53]
 v_cmp_u_f32_e64 vcc, v51, v55
 s_cbranch_vccnz Lkr1
Lkb1:
 s_add_u32 s88, s78, 0
 s_mov_b64 exec, 0xffff
 buffer_load_dword v14, v8, s[52:55], s88 offen
 s_mov_b64 exec, -1
 s_add_u32 s88, s78, 2048
 s_mov_b64 exec, 0xffff
 buffer_load_dword v14, v8, s[52:55], s88 offen
 s_mov_b64 exec, -1
 s_waitcnt lgkmcnt(0)
 s_barrier
 s_setprio 0
 s_add_u32 m0, s72, 0
 s_nop 0
 ds_write_addtid_b32 v96 offset:32768
 ds_write_addtid_b32 v97 offset:33024
 ds_write_addtid_b32 v98 offset:33280
 ds_write_addtid_b32 v99 offset:33536
 ds_write_addtid_b32 v100 offset:33792
 ds_write_addtid_b32 v101 offset:34048
 ds_write_addtid_b32 v102 offset:34304
 ds_write_addtid_b32 v103 offset:34560
 s_add_u32 m0, s73, 0
 s_nop 0
 ds_write_addtid_b32 v104 offset:32768
 ds_write_addtid_b32 v105 offset:33024
 ds_write_addtid_b32 v106 offset:33280
 ds_write_addtid_b32 v107 offset:33536
 ds_write_addtid_b32 v108 offset:33792
 ds_write_addtid_b32 v109 offset:34048
 ds_write_addtid_b32 v110 offset:34304
 s_waitcnt lgkmcnt(11)
 ds_write_addtid_b32 v111 offset:34560
 s_add_u32 m0, s74, 0
 s_nop 0
 ds_write_addtid_b32 v112 offset:32768
 ds_write_addtid_b32 v113 offset:33024
 ds_write_addtid_b32 v114 offset:33280
 s_waitcnt lgkmcnt(11)
 ds_write_addtid_b32 v115 offset:33536
 ds_write_addtid_b32 v116 offset:33792
 ds_write_addtid_b32 v117 offset:34048
 ds_write_addtid_b32 v118 offset:34304
 s_waitcnt lgkmcnt(11)
 ds_write_addtid_b32 v119 offset:34560
 s_add_u32 m0, s75, 0
 s_nop 0
 ds_write_addtid_b32 v120 offset:32768
 ds_write_addtid_b32 v121 offset:33024
 ds_write_addtid_b32 v122 offset:33280
 s_waitcnt lgkmcnt(11)
 ds_write_addtid_b32 v123 offset:33536
 ds_write_addtid_b32 v124 offset:33792
 ds_write_addtid_b32 v125 offset:34048
 ds_write_addtid_b32 v126 offset:34304
 s_waitcnt lgkmcnt(11)
 ds_write_addtid_b32 v127 offset:34560
 s_waitcnt lgkmcnt(0)
 s_barrier
 s_setprio 0
 s_add_u32 m0, s72, 34564
 s_nop 0
 ds_write_addtid_b32 v128 offset:63740
 ds_write_addtid_b32 v129 offset:63996
 ds_write_addtid_b32 v130 offset:64252
 ds_write_addtid_b32 v131 offset:64508
 ds_write_addtid_b32 v132 offset:64764
 ds_write_addtid_b32 v133 offset:65020
 ds_write_addtid_b32 v134 offset:65276
 ds_write_addtid_b32 v135 offset:65532
 s_add_u32 m0, s73, 34564
 s_nop 0
 ds_write_addtid_b32 v136 offset:63740
 ds_write_addtid_b32 v137 offset:63996
 ds_write_addtid_b32 v138 offset:64252
 ds_write_addtid_b32 v139 offset:64508
 ds_write_addtid_b32 v140 offset:64764
 ds_write_addtid_b32 v141 offset:65020
 ds_write_addtid_b32 v142 offset:65276
 s_waitcnt lgkmcnt(11)
 ds_write_addtid_b32 v143 offset:65532
 s_add_u32 m0, s74, 34564
 s_nop 0
 ds_write_addtid_b32 v144 offset:63740
 ds_write_addtid_b32 v145 offset:63996
 ds_write_addtid_b32 v146 offset:64252
 s_waitcnt lgkmcnt(11)
 ds_write_addtid_b32 v147 offset:64508
 ds_write_addtid_b32 v148 offset:64764
 ds_write_addtid_b32 v149 offset:65020
 ds_write_addtid_b32 v150 offset:65276
 s_waitcnt lgkmcnt(11)
 ds_write_addtid_b32 v151 offset:65532
 s_add_u32 m0, s75, 34564
 s_nop 0
 ds_write_addtid_b32 v152 offset:63740
 ds_write_addtid_b32 v153 offset:63996
 ds_write_addtid_b32 v154 offset:64252
 s_waitcnt lgkmcnt(11)
 ds_write_addtid_b32 v155 offset:64508
 ds_write_addtid_b32 v156 offset:64764
 ds_write_addtid_b32 v157 offset:65020
 ds_write_addtid_b32 v158 offset:65276
 s_waitcnt lgkmcnt(11)
 ds_write_addtid_b32 v159 offset:65532
 s_add_u32 m0, s72, 34564
 s_nop 0
 ds_write_addtid_b32 v160 offset:30972
 ds_write_addtid_b32 v161 offset:31228
 ds_write_addtid_b32 v162 offset:31484
 s_waitcnt lgkmcnt(11)
 ds_write_addtid_b32 v163 offset:31740
 ds_write_addtid_b32 v164 offset:31996
 ds_write_addtid_b32 v165 offset:32252
 ds_write_addtid_b32 v166 offset:32508
 s_waitcnt lgkmcnt(11)
 ds_write_addtid_b32 v167 offset:32764
 s_add_u32 m0, s73, 34564
 s_nop 0
 ds_write_addtid_b32 v168 offset:30972
 ds_write_addtid_b32 v169 offset:31228
 ds_write_addtid_b32 v170 offset:31484
 s_waitcnt lgkmcnt(11)
 ds_write_addtid_b32 v171 offset:31740
 ds_write_addtid_b32 v172 offset:31996
 ds_write_addtid_b32 v173 offset:32252
 ds_write_addtid_b32 v174 offset:32508
 s_waitcnt lgkmcnt(11)
 ds_write_addtid_b32 v175 offset:32764
 s_add_u32 m0, s74, 34564
 s_nop 0
 ds_write_addtid_b32 v176 offset:30972
 ds_write_addtid_b32 v177 offset:31228
 ds_write_addtid_b32 v178 offset:31484
 s_waitcnt lgkmcnt(11)
 ds_write_addtid_b32 v179 offset:31740
 ds_write_addtid_b32 v180 offset:31996
 ds_write_addtid_b32 v181 offset:32252
 ds_write_addtid_b32 v182 offset:32508
 s_waitcnt lgkmcnt(11)
 ds_write_addtid_b32 v183 offset:32764
 s_add_u32 m0, s75, 34564
 s_nop 0
 ds_write_addtid_b32 v184 offset:30972
 ds_write_addtid_b32 v185 offset:31228
 ds_write_addtid_b32 v186 offset:31484
 s_waitcnt lgkmcnt(11)
 ds_write_addtid_b32 v187 offset:31740
 ds_write_addtid_b32 v188 offset:31996
 ds_write_addtid_b32 v189 offset:32252
 ds_write_addtid_b32 v190 offset:32508
 s_waitcnt lgkmcnt(11)
 ds_write_addtid_b32 v191 offset:32764
 v_mov_b32 v11, 131072
 s_setprio 2
 s_waitcnt lgkmcnt(0)
 s_mov_b64 exec, 1
 ds_add_u32 v11, v11 offset:31232
 s_mov_b64 exec, -1
 s_branch Lhy34
Lhx33:
 s_sub_u32 s64, s64, 1
 s_cbranch_scc1 Lexit2
 s_sleep 1
Lhy34:
 ds_read_b32 v10, v11 offset:31232
 s_waitcnt lgkmcnt(0)
 v_readfirstlane_b32 s90, v10
 s_cmp_lt_u32 s90, 3145728
 s_cbranch_scc1 Lhx33
 s_add_u32 m0, s77, 0
 s_add_u32 s88, s76, 0
 buffer_load_dwordx4 v5, s[52:55], s88 offen lds
 s_add_u32 m0, s77, 4096
 s_add_u32 s88, s76, 65536
 buffer_load_dwordx4 v5, s[52:55], s88 offen lds
 s_add_u32 m0, s77, 8192
 s_add_u32 s88, s76, 131072
 buffer_load_dwordx4 v5, s[52:55], s88 offen lds
 s_add_u32 m0, s77, 12288
 s_add_u32 s88, s76, 196608
 buffer_load_dwordx4 v5, s[52:55], s88 offen lds
 s_add_u32 m0, s77, 16384
 s_add_u32 s88, s76, 262144
 buffer_load_dwordx4 v5, s[52:55], s88 offen lds
 s_add_u32 m0, s77, 20480
 s_add_u32 s88, s76, 327680
 buffer_load_dwordx4 v5, s[52:55], s88 offen lds
 s_add_u32 m0, s77, 24576
 s_add_u32 s88, s76, 393216
 buffer_load_dwordx4 v5, s[52:55], s88 offen lds
 s_add_u32 s4, s4, 655360
 s_add_u32 s6, s6, 655360
 s_add_u32 s91, s4, 4096
 s_barrier
 s_setprio 2
 s_add_u32 m0, s77, 28672
 s_add_u32 s88, s76, 458752
 buffer_load_dwordx4 v5, s[52:55], s88 offen lds
 s_add_u32 m0, s77, 32768
 s_add_u32 s88, s76, 16384
 buffer_load_dwordx4 v5, s[52:55], s88 offen lds
 s_add_u32 m0, s77, 36864
 s_add_u32 s88, s76, 81920
 buffer_load_dwordx4 v5, s[52:55], s88 offen lds
 s_waitcnt vmcnt(3)
 s_barrier
 s_add_u32 m0, s77, 40960
 s_add_u32 s88, s76, 147456
 buffer_load_dwordx4 v5, s[52:55], s88 offen lds
 s_add_u32 m0, s77, 45056
 s_add_u32 s88, s76, 212992
 buffer_load_dwordx4 v5, s[52:55], s88 offen lds
 s_add_u32 m0, s77, 49152
 s_add_u32 s88, s76, 278528
 buffer_load_dwordx4 v5, s[52:55], s88 offen lds
 s_add_u32 m0, s77, 53248
 s_add_u32 s88, s76, 344064
 buffer_load_dwordx4 v5, s[52:55], s88 offen lds
 s_add_u32 m0, s77, 57344
 s_add_u32 s88, s76, 409600
 buffer_load_dwordx4 v5, s[52:55], s88 offen lds
 s_waitcnt vmcnt(0)
 buffer_load_dwordx2 v[48:49], v15, s[28:31], s6 offen sc1
 buffer_load_dwordx4 v[16:19], v4, s[28:31], s4 offen offset:0 sc1
 buffer_load_dwordx4 v[20:23], v4, s[28:31], s4 offen offset:256 sc1
 buffer_load_dwordx4 v[24:27], v4, s[28:31], s4 offen offset:2048 sc1
 buffer_load_dwordx4 v[28:31], v4, s[28:31], s4 offen offset:2304 sc1
 buffer_load_dwordx4 v[32:35], v4, s[28:31], s91 offen offset:0 sc1
 buffer_load_dwordx4 v[36:39], v4, s[28:31], s91 offen offset:256 sc1
 buffer_load_dwordx4 v[40:43], v4, s[28:31], s91 offen offset:2048 sc1
 buffer_load_dwordx4 v[44:47], v4, s[28:31], s91 offen offset:2304 sc1
Lsk2:
 v_mov_b32 v50, 0
 v_mov_b32 v51, 0
 s_waitcnt vmcnt(8)
 v_mov_b32 v10, v48
 v_mfma_f32_16x16x32_bf16 v[48:51], v[56:59], v[48:51], 0
 s_waitcnt vmcnt(7)
 v_mfma_f32_16x16x32_bf16 v[52:55], v[56:59], v[16:19], 0
 s_add_u32 m0, s77, 61440
 s_add_u32 s88, s76, 475136
 buffer_load_dwordx4 v5, s[52:55], s88 offen lds
 s_waitcnt vmcnt(7)
 v_mfma_f32_16x16x32_bf16 v[52:55], v[60:63], v[20:23], v[52:55]
 s_waitcnt vmcnt(6)
 v_mfma_f32_16x16x32_bf16 v[52:55], v[56:59], v[24:27], v[52:55]
 s_waitcnt vmcnt(5)
 v_mfma_f32_16x16x32_bf16 v[52:55], v[60:63], v[28:31], v[52:55]
 v_add_f32_dpp v48, v48, v48 row_ror:4 row_mask:0xf bank_mask:0xf
 s_waitcnt vmcnt(4)
 v_mfma_f32_16x16x32_bf16 v[52:55], v[56:59], v[32:35], v[52:55]
 v_add_f32_dpp v49, v49, v49 row_ror:4 row_mask:0xf bank_mask:0xf
 s_waitcnt vmcnt(3)
 v_mfma_f32_16x16x32_bf16 v[52:55], v[60:63], v[36:39], v[52:55]
 v_add_f32_dpp v50, v50, v50 row_ror:4 row_mask:0xf bank_mask:0xf
 s_waitcnt vmcnt(2)
 v_mfma_f32_16x16x32_bf16 v[52:55], v[56:59], v[40:43], v[52:55]
 v_add_f32_dpp v51, v51, v51 row_ror:4 row_mask:0xf bank_mask:0xf
 s_waitcnt vmcnt(1)
 v_mfma_f32_16x16x32_bf16 v[52:55], v[60:63], v[44:47], v[52:55]
 v_add_f32_dpp v48, v48, v48 row_ror:8 row_mask:0xf bank_mask:0xf
 v_add_f32_dpp v49, v49, v49 row_ror:8 row_mask:0xf bank_mask:0xf
 v_add_f32_dpp v50, v50, v50 row_ror:8 row_mask:0xf bank_mask:0xf
 v_add_f32_dpp v51, v51, v51 row_ror:8 row_mask:0xf bank_mask:0xf
 v_cvt_pk_bf16_f32 v48, v48, v49
 v_cvt_pk_bf16_f32 v49, v50, v51
 ds_write_b64 v13, v[48:49]
 s_nop 0
 v_cvt_pk_bf16_f32 v52, v52, v53
 v_cvt_pk_bf16_f32 v53, v54, v55
 ds_write_b64 v12, v[52:53]
 v_cmp_u_f32 vcc, v51, v55
 s_cbranch_vccnz Lkr2
Lkb2:
 s_waitcnt vmcnt(0) lgkmcnt(0)
 s_barrier
 s_setprio 0
 s_add_u32 m0, s72, 34564
 s_nop 0
 ds_write_addtid_b32 v192 offset:63740
 ds_write_addtid_b32 v193 offset:63996
 ds_write_addtid_b32 v194 offset:64252
 ds_write_addtid_b32 v195 offset:64508
 ds_write_addtid_b32 v196 offset:64764
 ds_write_addtid_b32 v197 offset:65020
 ds_write_addtid_b32 v198 offset:65276
 ds_write_addtid_b32 v199 offset:65532
 s_add_u32 m0, s73, 34564
Lhop12:
 s_cbranch_execz Lhopret
 s_nop 0
 ds_write_addtid_b32 v200 offset:63740
 ds_write_addtid_b32 v201 offset:63996
 ds_write_addtid_b32 v202 offset:64252
 ds_write_addtid_b32 v203 offset:64508
 ds_write_addtid_b32 v204 offset:64764
 ds_write_addtid_b32 v205 offset:65020
 ds_write_addtid_b32 v206 offset:65276
 s_waitcnt lgkmcnt(11)
 ds_write_addtid_b32 v207 offset:65532
 s_add_u32 m0, s74, 34564
 s_nop 0
 ds_write_addtid_b32 v208 offset:63740
 ds_write_addtid_b32 v209 offset:63996
 ds_write_addtid_b32 v210 offset:64252
 s_waitcnt lgkmcnt(11)
 ds_write_addtid_b32 v211 offset:64508
 ds_write_addtid_b32 v212 offset:64764
 ds_write_addtid_b32 v213 offset:65020
 ds_write_addtid_b32 v214 offset:65276
 s_waitcnt lgkmcnt(11)
 ds_write_addtid_b32 v215 offset:65532
 s_add_u32 m0, s75, 34564
 s_nop 0
 ds_write_addtid_b32 v216 offset:63740
 ds_write_addtid_b32 v217 offset:63996
 ds_write_addtid_b32 v218 offset:64252
 s_waitcnt lgkmcnt(11)
 ds_write_addtid_b32 v219 offset:64508
 ds_write_addtid_b32 v220 offset:64764
 ds_write_addtid_b32 v221 offset:65020
 ds_write_addtid_b32 v222 offset:65276
 s_waitcnt lgkmcnt(11)
 ds_write_addtid_b32 v223 offset:65532
 s_waitcnt lgkmcnt(0)
 s_barrier
 s_setprio 0
 s_add_u32 m0, s72, 0
 s_nop 0
 ds_write_addtid_b32 v224 offset:32768
 ds_write_addtid_b32 v225 offset:33024
 ds_write_addtid_b32 v226 offset:33280
 ds_write_addtid_b32 v227 offset:33536
 ds_write_addtid_b32 v228 offset:33792
 ds_write_addtid_b32 v229 offset:34048
 ds_write_addtid_b32 v230 offset:34304
 ds_write_addtid_b32 v231 offset:34560
 s_add_u32 m0, s73, 0
 s_nop 0
 ds_write_addtid_b32 v232 offset:32768
 ds_write_addtid_b32 v233 offset:33024
 ds_write_addtid_b32 v234 offset:33280
 ds_write_addtid_b32 v235 offset:33536
 ds_write_addtid_b32 v236 offset:33792
 ds_write_addtid_b32 v237 offset:34048
 ds_write_addtid_b32 v238 offset:34304
 s_waitcnt lgkmcnt(11)
 ds_write_addtid_b32 v239 offset:34560
 s_add_u32 m0, s74, 0
 s_nop 0
 ds_write_addtid_b32 v240 offset:32768
 ds_write_addtid_b32 v241 offset:33024
 ds_write_addtid_b32 v242 offset:33280
 s_waitcnt lgkmcnt(11)
 ds_write_addtid_b32 v243 offset:33536
 ds_write_addtid_b32 v244 offset:33792
 ds_write_addtid_b32 v245 offset:34048
 ds_write_addtid_b32 v246 offset:34304
 s_waitcnt lgkmcnt(11)
 ds_write_addtid_b32 v247 offset:34560
 s_add_u32 m0, s75, 0
 s_nop 0
 ds_write_addtid_b32 v248 offset:32768
 ds_write_addtid_b32 v249 offset:33024
 ds_write_addtid_b32 v250 offset:33280
 s_waitcnt lgkmcnt(11)
 ds_write_addtid_b32 v251 offset:33536
 ds_write_addtid_b32 v252 offset:33792
 ds_write_addtid_b32 v253 offset:34048
 ds_write_addtid_b32 v254 offset:34304
 s_waitcnt lgkmcnt(11)
 ds_write_addtid_b32 v255 offset:34560
 v_mov_b32 v11, 131072
 s_setprio 2
 s_waitcnt lgkmcnt(0)
 s_mov_b64 exec, 1
 ds_add_u32 v11, v11 offset:31232
 s_mov_b64 exec, -1
 s_branch Lhy36
Lhx35:
 s_sub_u32 s64, s64, 1
 s_cbranch_scc1 Lexit2
 s_sleep 1
Lhy36:
 ds_read_b32 v10, v11 offset:31232
 s_waitcnt lgkmcnt(0)
 v_readfirstlane_b32 s90, v10
 s_cmp_lt_u32 s90, 4194304
 s_cbranch_scc1 Lhx35
 s_add_u32 m0, s77, 65536
 s_add_u32 s88, s76, 0
 buffer_load_dwordx4 v5, s[56:59], s88 offen lds
 s_add_u32 m0, s77, 69632
 s_add_u32 s88, s76, 65536
 buffer_load_dwordx4 v5, s[56:59], s88 offen lds
 s_add_u32 m0, s77, 73728
 s_add_u32 s88, s76, 131072
 buffer_load_dwordx4 v5, s[56:59], s88 offen lds
 s_add_u32 m0, s77, 77824
 s_add_u32 s88, s76, 196608
 buffer_load_dwordx4 v5, s[56:59], s88 offen lds
 s_add_u32 m0, s77, 81920
 s_add_u32 s88, s76, 262144
 buffer_load_dwordx4 v5, s[56:59], s88 offen lds
 s_add_u32 m0, s77, 86016
 s_add_u32 s88, s76, 327680
 buffer_load_dwordx4 v5, s[56:59], s88 offen lds
 s_add_u32 m0, s77, 90112
 s_add_u32 s88, s76, 393216
 buffer_load_dwordx4 v5, s[56:59], s88 offen lds
 s_add_u32 s4, s4, 655360
 s_add_u32 s6, s6, 655360
 s_add_u32 s91, s4, 4096
 s_barrier
 s_setprio 2
 s_add_u32 m0, s77, 94208
 s_add_u32 s88, s76, 458752
 buffer_load_dwordx4 v5, s[56:59], s88 offen lds
 s_add_u32 m0, s77, 98304
 s_add_u32 s88, s76, 16384
 buffer_load_dwordx4 v5, s[56:59], s88 offen lds
 s_add_u32 m0, s77, 102400
 s_add_u32 s88, s76, 81920
 buffer_load_dwordx4 v5, s[56:59], s88 offen lds
 s_waitcnt vmcnt(3)
 s_barrier
 s_add_u32 m0, s77, 106496
 s_add_u32 s88, s76, 147456
 buffer_load_dwordx4 v5, s[56:59], s88 offen lds
 s_add_u32 m0, s77, 110592
 s_add_u32 s88, s76, 212992
 buffer_load_dwordx4 v5, s[56:59], s88 offen lds
 s_add_u32 m0, s77, 114688
 s_add_u32 s88, s76, 278528
 buffer_load_dwordx4 v5, s[56:59], s88 offen lds
 s_add_u32 m0, s77, 118784
 s_add_u32 s88, s76, 344064
 buffer_load_dwordx4 v5, s[56:59], s88 offen lds
 s_add_u32 m0, s77, 122880
 s_add_u32 s88, s76, 409600
 buffer_load_dwordx4 v5, s[56:59], s88 offen lds
 s_waitcnt vmcnt(0)
 buffer_load_dwordx2 v[48:49], v15, s[28:31], s6 offen sc1
 buffer_load_dwordx4 v[16:19], v4, s[28:31], s4 offen offset:0 sc1
 buffer_load_dwordx4 v[20:23], v4, s[28:31], s4 offen offset:256 sc1
 buffer_load_dwordx4 v[24:27], v4, s[28:31], s4 offen offset:2048 sc1
 buffer_load_dwordx4 v[28:31], v4, s[28:31], s4 offen offset:2304 sc1
 buffer_load_dwordx4 v[32:35], v4, s[28:31], s91 offen offset:0 sc1
 buffer_load_dwordx4 v[36:39], v4, s[28:31], s91 offen offset:256 sc1
 buffer_load_dwordx4 v[40:43], v4, s[28:31], s91 offen offset:2048 sc1
 buffer_load_dwordx4 v[44:47], v4, s[28:31], s91 offen offset:2304 sc1
Lsk3:
 v_mov_b32 v50, 0
 v_mov_b32 v51, 0
 s_waitcnt vmcnt(8)
 v_mov_b32_e64 v10, v48
 v_mfma_f32_16x16x32_bf16 v[48:51], v[56:59], v[48:51], 0
 s_waitcnt vmcnt(7)
 v_mfma_f32_16x16x32_bf16 v[52:55], v[56:59], v[16:19], 0
 s_add_u32 m0, s77, 126976
 s_add_u32 s88, s76, 475136
 buffer_load_dwordx4 v5, s[56:59], s88 offen lds
 s_waitcnt vmcnt(7)
 v_mfma_f32_16x16x32_bf16 v[52:55], v[60:63], v[20:23], v[52:55]
 s_waitcnt vmcnt(6)
 v_mfma_f32_16x16x32_bf16 v[52:55], v[56:59], v[24:27], v[52:55]
 s_waitcnt vmcnt(5)
 v_mfma_f32_16x16x32_bf16 v[52:55], v[60:63], v[28:31], v[52:55]
 v_add_f32_dpp v48, v48, v48 row_ror:4 row_mask:0xf bank_mask:0xf
 s_waitcnt vmcnt(4)
 v_mfma_f32_16x16x32_bf16 v[52:55], v[56:59], v[32:35], v[52:55]
 v_add_f32_dpp v49, v49, v49 row_ror:4 row_mask:0xf bank_mask:0xf
 s_waitcnt vmcnt(3)
 v_mfma_f32_16x16x32_bf16 v[52:55], v[60:63], v[36:39], v[52:55]
 v_add_f32_dpp v50, v50, v50 row_ror:4 row_mask:0xf bank_mask:0xf
 s_waitcnt vmcnt(2)
 v_mfma_f32_16x16x32_bf16 v[52:55], v[56:59], v[40:43], v[52:55]
 v_add_f32_dpp v51, v51, v51 row_ror:4 row_mask:0xf bank_mask:0xf
 s_waitcnt vmcnt(1)
 v_mfma_f32_16x16x32_bf16 v[52:55], v[60:63], v[44:47], v[52:55]
 v_add_f32_dpp v48, v48, v48 row_ror:8 row_mask:0xf bank_mask:0xf
 v_add_f32_dpp v49, v49, v49 row_ror:8 row_mask:0xf bank_mask:0xf
 v_add_f32_dpp v50, v50, v50 row_ror:8 row_mask:0xf bank_mask:0xf
 v_add_f32_dpp v51, v51, v51 row_ror:8 row_mask:0xf bank_mask:0xf
 v_cvt_pk_bf16_f32 v48, v48, v49
 v_cvt_pk_bf16_f32 v49, v50, v51
 ds_write_b64 v13, v[48:49]
 s_nop 0
 v_cvt_pk_bf16_f32 v52, v52, v53
 v_cvt_pk_bf16_f32 v53, v54, v55
 ds_write_b64 v12, v[52:53]
 v_cmp_u_f32_e64 vcc, v51, v55
 s_cbranch_vccnz Lkr3
Lkb3:
 s_waitcnt vmcnt(0) lgkmcnt(0)
 s_barrier
 s_setprio 0
 s_endpgm
Ltail:
Lax2:
 ds_read_b128 v[124:127], v12 offset:16
 s_sub_u32 s64, s64, 1
 s_cbranch_scc1 Lexit2
 s_waitcnt lgkmcnt(0)
 v_min3_u32 v124, v124, v125, v126
 v_min_u32 v124, v124, v127
 v_cmp_gt_u32 vcc, 1, v124
 s_branch Law1
Lax4:
 ds_read_b128 v[124:127], v12 offset:16
 s_sub_u32 s64, s64, 1
 s_cbranch_scc1 Lexit2
 s_waitcnt lgkmcnt(0)
 v_min3_u32 v124, v124, v125, v126
 v_min_u32 v124, v124, v127
 v_cmp_gt_u32 vcc, 2, v124
 s_branch Law3
Lax6:
 ds_read_b128 v[124:127], v12 offset:16
 s_sub_u32 s64, s64, 1
 s_cbranch_scc1 Lexit2
 s_waitcnt lgkmcnt(0)
 v_min3_u32 v124, v124, v125, v126
 v_min_u32 v124, v124, v127
 v_cmp_gt_u32 vcc, 3, v124
 s_branch Law5
Lax8:
 ds_read_b128 v[124:127], v12 offset:16
 s_sub_u32 s64, s64, 1
 s_cbranch_scc1 Lexit2
 s_waitcnt lgkmcnt(0)
 v_min3_u32 v124, v124, v125, v126
 v_min_u32 v124, v124, v127
 v_cmp_gt_u32 vcc, 4, v124
 s_branch Law7
Lax10:
 ds_read_b128 v[124:127], v12 offset:32
 s_sub_u32 s64, s64, 1
 s_cbranch_scc1 Lexit2
 s_waitcnt lgkmcnt(0)
 v_min3_u32 v124, v124, v125, v126
 v_min_u32 v124, v124, v127
 v_cmp_gt_u32 vcc, 3, v124
 s_branch Law9
Lxc11:
 buffer_load_dwordx4 v[248:251], v1, s[28:31], s76 offen offset:0 sc1
 ds_read_b64_tr_b16 v[88:89], v2 offset:0
 ds_read_b64_tr_b16 v[90:91], v2 offset:1024
 ds_read_b64_tr_b16 v[92:93], v2 offset:32768
 buffer_load_dwordx4 v[128:131], v1, s[36:39], s68 offen offset:0 sc1
 ds_read_b64_tr_b16 v[94:95], v2 offset:33792
 ds_read_b64_tr_b16 v[96:97], v2 offset:512
 buffer_load_dwordx4 v[132:135], v1, s[36:39], s68 offen offset:1024 sc1
 ds_read_b64_tr_b16 v[98:99], v2 offset:1536
 ds_read_b64_tr_b16 v[100:101], v2 offset:33280
 ds_read_b64_tr_b16 v[102:103], v2 offset:34304
 buffer_load_dwordx4 v[136:139], v1, s[36:39], s68 offen offset:2048 sc1
 ds_read_b64_tr_b16 v[104:105], v2 offset:2048
 ds_read_b64_tr_b16 v[106:107], v2 offset:3072
 buffer_load_dwordx4 v[140:143], v1, s[36:39], s68 offen offset:3072 sc1
 ds_read_b64_tr_b16 v[108:109], v2 offset:34816
 ds_read_b64_tr_b16 v[110:111], v2 offset:35840
 s_sub_u32 s64, s64, 1
 s_cbranch_scc1 Lexit2
 s_branch Lxw12
Lrt13:
 s_sub_u32 s64, s64, 1
 s_cbranch_scc1 Lexit2
 s_waitcnt lgkmcnt(0)
 s_branch Lxc11
Lrt14:
 s_sub_u32 s64, s64, 1
 s_cbranch_scc1 Lexit2
 s_waitcnt lgkmcnt(0)
 s_branch Lxc11
.fill 55, 4, 0xbf810000
Lhop13:
 s_cbranch_execz Lhopret
Lxb16:
 s_nop 7
 v_xor_b32 v240, 0x80008000, v240
 v_xor_b32 v241, 0x80008000, v241
 v_xor_b32 v242, 0x80008000, v242
 v_xor_b32 v243, 0x80008000, v243
 v_xor_b32 v244, 0x80008000, v244
 v_xor_b32 v245, 0x80008000, v245
 v_xor_b32 v246, 0x80008000, v246
 v_xor_b32 v247, 0x80008000, v247
 v_xor_b32 v248, 0x80008000, v248
 v_xor_b32 v249, 0x80008000, v249
 v_xor_b32 v250, 0x80008000, v250
 v_xor_b32 v251, 0x80008000, v251
 v_xor_b32 v252, 0x80008000, v252
 v_xor_b32 v253, 0x80008000, v253
 v_xor_b32 v254, 0x80008000, v254
 v_xor_b32 v255, 0x80008000, v255
 v_mfma_f32_32x32x16_bf16 v[56:71], v[88:91], v[240:243], v[56:71]
 v_mfma_f32_32x32x16_bf16 v[72:87], v[92:95], v[240:243], v[72:87]
 v_mfma_f32_32x32x16_bf16 v[56:71], v[96:99], v[244:247], v[56:71]
 v_mfma_f32_32x32x16_bf16 v[72:87], v[100:103], v[244:247], v[72:87]
 v_mfma_f32_32x32x16_bf16 v[56:71], v[104:107], v[248:251], v[56:71]
 v_mfma_f32_32x32x16_bf16 v[72:87], v[108:111], v[248:251], v[72:87]
 v_mfma_f32_32x32x16_bf16 v[56:71], v[112:115], v[252:255], v[56:71]
 s_nop 15
Lxd17:
 buffer_load_dwordx4 v[240:243], v1, s[36:39], s75 offen offset:0 sc1
 buffer_load_dwordx4 v[244:247], v1, s[36:39], s75 offen offset:1024 sc1
 buffer_load_dwordx4 v[248:251], v1, s[36:39], s75 offen offset:2048 sc1
 buffer_load_dwordx4 v[252:255], v1, s[36:39], s75 offen offset:3072 sc1
 s_sub_u32 s64, s64, 1
 s_cbranch_scc1 Lexit2
 s_waitcnt vmcnt(0)
 v_bitop3_b32 v18, v243, v247, s65 bitop3:0x7e
 v_bitop3_b32 v18, v251, v18, s65 bitop3:0xde
 v_bitop3_b32 v18, v255, v18, s65 bitop3:0xde
 v_and_b32 v20, 1, v18
 v_cmp_ne_u32_e64 vcc, 0, v20
 s_cbranch_vccnz Lxd17
 v_mfma_f32_32x32x16_bf16 v[56:71], v[88:91], v[240:243], v[56:71]
 v_mfma_f32_32x32x16_bf16 v[72:87], v[92:95], v[240:243], v[72:87]
 v_mfma_f32_32x32x16_bf16 v[56:71], v[96:99], v[244:247], v[56:71]
 v_mfma_f32_32x32x16_bf16 v[72:87], v[100:103], v[244:247], v[72:87]
 v_mfma_f32_32x32x16_bf16 v[56:71], v[104:107], v[248:251], v[56:71]
 v_mfma_f32_32x32x16_bf16 v[72:87], v[108:111], v[248:251], v[72:87]
 v_mfma_f32_32x32x16_bf16 v[56:71], v[112:115], v[252:255], v[56:71]
 s_nop 3
 s_branch Lxa15
Lsl18:
 v_add_f32 v96, 0x358637bd, v96
 v_rcp_f32 v96, v96
 s_nop 0
 v_mul_f32 v88, v88, v96
 v_mul_f32 v89, v89, v96
 v_mul_f32 v90, v90, v96
 v_mul_f32 v91, v91, v96
 v_mul_f32 v92, v92, v96
 v_mul_f32 v93, v93, v96
 v_mul_f32 v94, v94, v96
 v_mul_f32 v95, v95, v96
 v_cvt_pk_bf16_f32 v120, v88, v89
 v_cvt_pk_bf16_f32 v121, v90, v91
 v_cvt_pk_bf16_f32 v122, v92, v93
 v_cvt_pk_bf16_f32 v123, v94, v95
 v_and_or_b32 v123, v123, -2, s65
 buffer_store_dwordx4 v[120:123], v1, s[28:31], s10 offen sc1
 v_add_f32 v112, 0x358637bd, v112
 v_rcp_f32 v112, v112
 s_nop 0
 v_pk_mul_f32 v[104:105], v[104:105], v[112:113] op_sel_hi:[1,0]
 v_pk_mul_f32 v[106:107], v[106:107], v[112:113] op_sel_hi:[1,0]
 v_pk_mul_f32 v[108:109], v[108:109], v[112:113] op_sel_hi:[1,0]
 v_pk_mul_f32 v[110:111], v[110:111], v[112:113] op_sel_hi:[1,0]
 v_cvt_pk_bf16_f32 v124, v104, v105
 v_cvt_pk_bf16_f32 v125, v106, v107
 v_cvt_pk_bf16_f32 v126, v108, v109
 v_cvt_pk_bf16_f32 v127, v110, v111
 v_and_or_b32 v127, v127, -2, s65
 s_mov_b64 exec, 1
 buffer_store_dword v6, v0, s[28:31], s13 offen sc1
 s_mov_b64 exec, -1
 buffer_store_dwordx4 v[124:127], v1, s[28:31], s15 offen sc1
 s_branch Lbk19
Lrt21:
 s_sub_u32 s64, s64, 1
 s_cbranch_scc1 Lexit2
 s_waitcnt lgkmcnt(0)
 ds_read_b64_tr_b16 v[128:129], v4 offset:0
 ds_read_b64_tr_b16 v[130:131], v4 offset:1024
 ds_read_b64_tr_b16 v[132:133], v12 offset:0
 ds_read_b64_tr_b16 v[134:135], v12 offset:1024
 ds_read_b64_tr_b16 v[136:137], v13 offset:0
 ds_read_b64_tr_b16 v[138:139], v13 offset:1024
 ds_read_b64_tr_b16 v[140:141], v15 offset:0
 ds_read_b64_tr_b16 v[142:143], v15 offset:1024
 s_waitcnt lgkmcnt(0)
 s_waitcnt lgkmcnt(0)
 s_branch Loc20
Lrt22:
 s_sub_u32 s64, s64, 1
 s_cbranch_scc1 Lexit2
 s_waitcnt lgkmcnt(0)
 ds_read_b64_tr_b16 v[128:129], v4 offset:0
 ds_read_b64_tr_b16 v[130:131], v4 offset:1024
 ds_read_b64_tr_b16 v[132:133], v12 offset:0
 ds_read_b64_tr_b16 v[134:135], v12 offset:1024
 ds_read_b64_tr_b16 v[136:137], v13 offset:0
 ds_read_b64_tr_b16 v[138:139], v13 offset:1024
 ds_read_b64_tr_b16 v[140:141], v15 offset:0
 ds_read_b64_tr_b16 v[142:143], v15 offset:1024
 s_waitcnt lgkmcnt(0)
 ds_read_b64_tr_b16 v[144:145], v4 offset:4096
 ds_read_b64_tr_b16 v[146:147], v4 offset:5120
 ds_read_b64_tr_b16 v[148:149], v12 offset:4096
 ds_read_b64_tr_b16 v[150:151], v12 offset:5120
 ds_read_b64_tr_b16 v[152:153], v13 offset:4096
 ds_read_b64_tr_b16 v[154:155], v13 offset:5120
 ds_read_b64_tr_b16 v[156:157], v15 offset:4096
 ds_read_b64_tr_b16 v[158:159], v15 offset:5120
 s_waitcnt lgkmcnt(0)
 ds_read_b64_tr_b16 v[160:161], v4 offset:8192
 ds_read_b64_tr_b16 v[162:163], v4 offset:9216
 ds_read_b64_tr_b16 v[164:165], v12 offset:8192
 ds_read_b64_tr_b16 v[166:167], v12 offset:9216
 ds_read_b64_tr_b16 v[168:169], v13 offset:8192
 ds_read_b64_tr_b16 v[170:171], v13 offset:9216
 ds_read_b64_tr_b16 v[172:173], v15 offset:8192
 ds_read_b64_tr_b16 v[174:175], v15 offset:9216
 s_waitcnt lgkmcnt(0)
 ds_read_b64_tr_b16 v[176:177], v4 offset:12288
 ds_read_b64_tr_b16 v[178:179], v4 offset:13312
 ds_read_b64_tr_b16 v[180:181], v12 offset:12288
 ds_read_b64_tr_b16 v[182:183], v12 offset:13312
 ds_read_b64_tr_b16 v[184:185], v13 offset:12288
 ds_read_b64_tr_b16 v[186:187], v13 offset:13312
 ds_read_b64_tr_b16 v[188:189], v15 offset:12288
 ds_read_b64_tr_b16 v[190:191], v15 offset:13312
 s_waitcnt lgkmcnt(0)
 ds_read_b64_tr_b16 v[192:193], v4 offset:16384
 ds_read_b64_tr_b16 v[194:195], v4 offset:17408
 ds_read_b64_tr_b16 v[196:197], v12 offset:16384
 ds_read_b64_tr_b16 v[198:199], v12 offset:17408
 ds_read_b64_tr_b16 v[200:201], v13 offset:16384
 ds_read_b64_tr_b16 v[202:203], v13 offset:17408
 ds_read_b64_tr_b16 v[204:205], v15 offset:16384
 ds_read_b64_tr_b16 v[206:207], v15 offset:17408
 s_waitcnt lgkmcnt(0)
 ds_read_b64_tr_b16 v[208:209], v4 offset:20480
 ds_read_b64_tr_b16 v[210:211], v4 offset:21504
 ds_read_b64_tr_b16 v[212:213], v12 offset:20480
 ds_read_b64_tr_b16 v[214:215], v12 offset:21504
 ds_read_b64_tr_b16 v[216:217], v13 offset:20480
 ds_read_b64_tr_b16 v[218:219], v13 offset:21504
 ds_read_b64_tr_b16 v[220:221], v15 offset:20480
 ds_read_b64_tr_b16 v[222:223], v15 offset:21504
 s_waitcnt lgkmcnt(0)
 ds_read_b64_tr_b16 v[72:73], v4 offset:24576
 ds_read_b64_tr_b16 v[74:75], v4 offset:25600
 ds_read_b64_tr_b16 v[76:77], v12 offset:24576
 ds_read_b64_tr_b16 v[78:79], v12 offset:25600
 ds_read_b64_tr_b16 v[80:81], v13 offset:24576
 ds_read_b64_tr_b16 v[82:83], v13 offset:25600
 ds_read_b64_tr_b16 v[84:85], v15 offset:24576
 ds_read_b64_tr_b16 v[86:87], v15 offset:25600
 s_waitcnt lgkmcnt(0)
 ds_read_b64_tr_b16 v[88:89], v4 offset:28672
 ds_read_b64_tr_b16 v[90:91], v4 offset:29696
 s_waitcnt lgkmcnt(0)
 s_branch Loc20
Lslow:
 v_cvt_pk_bf16_f32 v123, v62, v63
 v_cvt_pk_bf16_f32 v120, v56, v57
 v_and_or_b32 v123, v123, -2, s65
 v_cvt_pk_bf16_f32 v121, v58, v59
 v_cvt_pk_bf16_f32 v122, v60, v61
 s_nop 1
 v_mfma_f32_16x16x32_bf16 v[96:99], v[120:123], v[120:123], 0
 v_mfma_f32_16x16x32_bf16 v[92:95], v[88:91], v[120:123], 0
 buffer_store_dwordx4 v[120:123], v31, s[36:39], s11 offen offset:0 sc1
 v_cvt_pk_bf16_f32 v127, v70, v71
 v_cvt_pk_bf16_f32 v124, v64, v65
 v_and_or_b32 v127, v127, -2, s65
 v_cvt_pk_bf16_f32 v125, v66, v67
 v_cvt_pk_bf16_f32 v126, v68, v69
 s_nop 1
 v_mfma_f32_16x16x32_bf16 v[96:99], v[124:127], v[124:127], v[96:99]
 v_mfma_f32_16x16x32_bf16 v[92:95], v[88:91], v[124:127], v[92:95]
 buffer_store_dwordx4 v[124:127], v31, s[36:39], s11 offen offset:2048 sc1
 s_nop 5
 v_cndmask_b32 v96, v96, v97, s[44:45]
 v_cndmask_b32 v98, v98, v99, s[44:45]
 v_cndmask_b32 v96, v96, v98, s[46:47]
 v_mul_f32 v92, 0.125, v92
 v_fma_f32 v96, -v92, v92, v96
 v_cvt_pk_bf16_f32 v92, v92, v96
 v_and_or_b32 v92, v92, -2, s65
 buffer_store_dword v92, v29, s[28:31], s12 offen sc1
 s_branch Lnext
Lkv2:
 v_cmp_eq_u32 vcc, -1, v10
 v_max3_u32 v10, v16, v18, v20
 v_max_u32_e64 v10, v22, v10
 v_cmp_eq_u32 s[18:19], -1, v10
 v_max3_u32 v10, v24, v26, v28
 v_max_u32_e64 v10, v30, v10
 v_cmp_eq_u32 s[20:21], -1, v10
 v_max3_u32 v10, v32, v34, v36
 v_max_u32_e64 v10, v38, v10
 v_cmp_eq_u32 s[22:23], -1, v10
 v_max3_u32 v10, v40, v42, v44
 v_max_u32_e64 v10, v46, v10
 v_cmp_eq_u32 s[24:25], -1, v10
 s_waitcnt lgkmcnt(0)
 buffer_load_dwordx2 v[48:49], v15, s[28:31], s6 offen sc1
 s_or_b64 vcc, vcc, s[18:19]
 s_mov_b64 exec, s[18:19]
 s_cbranch_execz Lkvn0
 buffer_load_dwordx4 v[16:19], v4, s[28:31], s4 offen offset:0 sc1
 buffer_load_dwordx4 v[20:23], v4, s[28:31], s4 offen offset:256 sc1
Lkvn0:
 s_or_b64 vcc, vcc, s[20:21]
 s_mov_b64 exec, s[20:21]
 s_cbranch_execz Lkvn1
 buffer_load_dwordx4 v[24:27], v4, s[28:31], s4 offen offset:2048 sc1
 buffer_load_dwordx4 v[28:31], v4, s[28:31], s4 offen offset:2304 sc1
Lkvn1:
 s_or_b64 vcc, vcc, s[22:23]
 s_mov_b64 exec, s[22:23]
 s_cbranch_execz Lkvn2
 buffer_load_dwordx4 v[32:35], v4, s[28:31], s91 offen offset:0 sc1
 buffer_load_dwordx4 v[36:39], v4, s[28:31], s91 offen offset:256 sc1
Lkvn2:
 s_or_b64 vcc, vcc, s[24:25]
 s_mov_b64 exec, s[24:25]
 s_cbranch_execz Lkvn3
 buffer_load_dwordx4 v[40:43], v4, s[28:31], s91 offen offset:2048 sc1
 buffer_load_dwordx4 v[44:47], v4, s[28:31], s91 offen offset:2304 sc1
Lkvn3:
 s_mov_b64 exec, -1
 s_cselect_b64 s[18:19], -1, 0
 s_sub_u32 s64, s64, 1
 s_cbranch_scc1 Lexit2
 v_mov_b32 v50, 0
 v_mov_b32 v51, 0
 s_waitcnt vmcnt(0)
 v_mov_b32_e64 v10, v48
 v_mfma_f32_16x16x32_bf16 v[48:51], v[56:59], v[48:51], 0
 s_nop 0
 v_mfma_f32_16x16x32_bf16 v[52:55], v[56:59], v[16:19], 0
 s_nop 0
 v_mfma_f32_16x16x32_bf16 v[52:55], v[60:63], v[20:23], v[52:55]
 s_nop 0
 v_mfma_f32_16x16x32_bf16 v[52:55], v[56:59], v[24:27], v[52:55]
 s_nop 0
 v_mfma_f32_16x16x32_bf16 v[52:55], v[60:63], v[28:31], v[52:55]
 v_add_f32_dpp v48, v48, v48 row_ror:4 row_mask:0xf bank_mask:0xf
 v_mfma_f32_16x16x32_bf16 v[52:55], v[56:59], v[32:35], v[52:55]
 v_add_f32_dpp v49, v49, v49 row_ror:4 row_mask:0xf bank_mask:0xf
 v_mfma_f32_16x16x32_bf16 v[52:55], v[60:63], v[36:39], v[52:55]
 v_add_f32_dpp v50, v50, v50 row_ror:4 row_mask:0xf bank_mask:0xf
 v_mfma_f32_16x16x32_bf16 v[52:55], v[56:59], v[40:43], v[52:55]
 v_add_f32_dpp v51, v51, v51 row_ror:4 row_mask:0xf bank_mask:0xf
 v_mfma_f32_16x16x32_bf16 v[52:55], v[60:63], v[44:47], v[52:55]
 v_add_f32_dpp v48, v48, v48 row_ror:8 row_mask:0xf bank_mask:0xf
 v_add_f32_dpp v49, v49, v49 row_ror:8 row_mask:0xf bank_mask:0xf
 v_add_f32_dpp v50, v50, v50 row_ror:8 row_mask:0xf bank_mask:0xf
 v_add_f32_dpp v51, v51, v51 row_ror:8 row_mask:0xf bank_mask:0xf
 v_cvt_pk_bf16_f32 v48, v48, v49
 v_cvt_pk_bf16_f32 v49, v50, v51
 ds_write_b64 v13, v[48:49]
 s_nop 0
 v_cvt_pk_bf16_f32 v52, v52, v53
 v_cvt_pk_bf16_f32 v53, v54, v55
 ds_write_b64 v12, v[52:53]
 v_cmp_u_f32_e64 vcc, v51, v55
 s_and_b64 vcc, vcc, s[18:19]
 s_cbranch_scc1 Lkv2
 s_setpc_b64 s[16:17]
Lax24:
 ds_read_b128 v[244:247], v233 offset:32
 s_sub_u32 s64, s64, 1
 s_cbranch_scc1 Lexit2
 s_waitcnt lgkmcnt(0)
 v_min3_u32 v244, v244, v245, v246
 v_min_u32 v244, v244, v247
 v_cmp_gt_u32_e64 vcc, 2, v244
 s_branch Law23
Lfretry:
 s_sub_u32 s64, s64, 1
 s_cbranch_scc1 Lexit2
 s_add_u32 s66, s66, 1
 s_and_b32 s88, s66, 15
 s_or_b32 s88, s88, s60
 s_cmp_lg_u32 s88, 0
 s_cbranch_scc1 Lfpoll
 buffer_wbl2 sc1
 s_waitcnt vmcnt(0)
 buffer_inv sc1
 s_waitcnt vmcnt(0)
 s_branch Lfpoll
Lfpoll:
 buffer_load_dwordx4 v[236:239], v228, s[32:35], s15 offen sc1
 s_waitcnt vmcnt(0)
 s_branch Lfchk
Lsl27:
 buffer_store_dwordx4 v[224:227], v1, s[28:31], s10 offen offset:0 sc1
 s_add_u32 s88, s10, 16384
 buffer_store_dwordx4 v[224:227], v1, s[28:31], s88 offen offset:0 sc1
 buffer_store_dwordx4 v[228:231], v1, s[36:39], s11 offen offset:0 sc1
 buffer_store_dwordx4 v[228:231], v1, s[36:39], s11 offen offset:1024 sc1
 s_mov_b64 exec, 0xff
 buffer_store_dwordx4 v[228:231], v1, s[28:31], s12 offen sc1
 s_mov_b64 exec, -1
 s_branch Lbk28
Lsl29:
 s_lshl_b32 s88, s62, 2
 s_add_u32 s88, s88, s13
 s_mov_b64 exec, 1
 buffer_store_dword v250, v1, s[28:31], s88 offen sc1
 s_mov_b64 exec, -1
 s_branch Lbk30
Lhop14:
 s_cbranch_execz Lhopret
Lgchk2:
 s_sub_u32 s64, s64, 1
 s_cbranch_scc1 Lexit2
 s_add_u32 s66, s66, 1
 s_and_b32 s88, s66, 31
 s_cmp_lg_u32 s88, 0
 s_cbranch_scc1 Lgchk3
 buffer_wbl2 sc1
 s_waitcnt vmcnt(0)
 buffer_inv sc1
Lgchk3:
 buffer_load_ubyte v242, v243, s[32:35], 0 offen sc1
 s_waitcnt vmcnt(0)
 s_branch Lgchk
Lkr0:
 s_call_b64 s[16:17], Lkv2
 s_branch Lkb0
Lc2r:
 buffer_load_dword v248, v249, s[28:31], s13 offen sc1
 s_sub_u32 s64, s64, 1
 s_cbranch_scc1 Lexit2
 s_waitcnt vmcnt(0)
 s_branch Lc2
Lkr1:
 s_call_b64 s[16:17], Lkv2
 s_branch Lkb1
Lkr2:
 s_call_b64 s[16:17], Lkv2
 s_branch Lkb2
Lkr3:
 s_call_b64 s[16:17], Lkv2
 s_branch Lkb3
Lend:
.section .rodata,"a"
.p2align 6
.amdhsa_kernel interleave_layers__linear_kernel_hedgehog__linear_kernel_hedgehog__prompt_kernel
.amdhsa_next_free_vgpr 256
.amdhsa_next_free_sgpr 102
.amdhsa_accum_offset 256
.amdhsa_group_segment_fixed_size 0
.amdhsa_kernarg_size 88
.amdhsa_user_sgpr_count 2
.amdhsa_user_sgpr_kernarg_segment_ptr 1
.amdhsa_system_sgpr_workgroup_id_x 1
.end_amdhsa_kernel
```
